```python
import torch

def _softmax(x, axis=-1):
    return torch.softmax(x, dim=axis)

def _gelu(x):
    return torch.nn.functional.gelu(x, approximate='tanh')

def _silu(x):
    return torch.nn.functional.silu(x)

def _sigmoid(x):
    return torch.sigmoid(x)

def _layernorm(x, axis=-1, eps=1e-05):
    m = x.mean(dim=axis, keepdim=True)
    v = x.var(dim=axis, keepdim=True, unbiased=False)
    return (x - m) / torch.sqrt(v + eps)

def _scatter_add(tgt, idx, src, axis=0):
    return tgt.clone().index_add_(axis, idx, src)

def _segment_sum(src, seg, n):
    out = torch.zeros((n,) + src.shape[1:], dtype=src.dtype)
    return out.index_add_(0, seg, src)

def _pad(x, pw):
    flat = tuple((v for pair in reversed(pw) for v in pair))
    return torch.nn.functional.pad(x, flat)
kernel_name = 'adaLN_cond__compressed_kv_cla__swiglu_ffn__decode'

def setup_inputs():

    _w = lambda a: (lambda t: t.to(torch.bfloat16) if t.is_floating_point() else t)(torch.as_tensor(a))

    def _A_setup():
        B, H, Sq, Sk, D, M = (2, 32, 1, 8192, 128, 640)
        Dc = 4 * D
        return {'x': _w((lambda *s: torch.randn(*s, dtype=torch.bfloat16) * 0.05)(B, Sq, M)), 'c_kv': _w((lambda *s: torch.randn(*s, dtype=torch.bfloat16) * 1.6)(B, Sk, Dc)), 'w_q': _w((lambda *s: torch.randn(*s, dtype=torch.bfloat16) * 1.6)(M, H, D) * M ** (-0.5)), 'w_uk': _w((lambda *s: torch.randn(*s, dtype=torch.bfloat16) * 1.6)(Dc, H, D) * Dc ** (-0.5)), 'w_uv': _w((lambda *s: torch.randn(*s, dtype=torch.bfloat16) * 1.6)(Dc, H, D) * Dc ** (-0.5)), 'w_o': _w((lambda *s: torch.randn(*s, dtype=torch.bfloat16) * 1.6)(H, D, M) * (H * D) ** (-0.5))}
    _A_in = _A_setup()

    def _B_setup():
        B, S, D, F = (2, 1, 640, 1728)
        return {'x': _w((lambda *s: torch.randn(*s, dtype=torch.bfloat16) * 0.05)(B, S, D)), 'w_gate': _w((lambda *s: torch.randn(*s, dtype=torch.bfloat16) * 0.05)(D, F)), 'w_up': _w((lambda *s: torch.randn(*s, dtype=torch.bfloat16) * 0.05)(D, F)), 'w_down': _w((lambda *s: torch.randn(*s, dtype=torch.bfloat16) * 0.05)(F, D))}
    _B_in = _B_setup()
    return {'A_x': _A_in['x'], 'A_c_kv': _A_in['c_kv'], 'A_w_q': _A_in['w_q'], 'A_w_uk': _A_in['w_uk'], 'A_w_uv': _A_in['w_uv'], 'A_w_o': _A_in['w_o'], 'B_x': _B_in['x'], 'B_w_gate': _B_in['w_gate'], 'B_w_up': _B_in['w_up'], 'B_w_down': _B_in['w_down'], 'c': _w((lambda *s: torch.randn(*s, dtype=torch.bfloat16) * 0.2)(2, 640) * 8.0), 'w_mod': _w((lambda *s: torch.randn(*s, dtype=torch.bfloat16) * 0.2)(640, 6 * 640) * 640 ** (-0.5) * 8.0)}

def reference(A_x, A_c_kv, A_w_q, A_w_uk, A_w_uv, A_w_o, B_x, B_w_gate, B_w_up, B_w_down, c, w_mod):

    def _A_ref(x, c_kv, w_q, w_uk, w_uv, w_o):
        B, Sq, M = (x.shape[0], x.shape[1], x.shape[2])
        Sk = c_kv.shape[1]
        H, D = (w_q.shape[1], w_q.shape[2])
        q = torch.einsum('bqm,mhd->bhqd', x, w_q)
        k = torch.einsum('bkc,chd->bhkd', c_kv, w_uk)
        v = torch.einsum('bkc,chd->bhkd', c_kv, w_uv)
        scores = torch.einsum('bhqd,bhkd->bhqk', q, k) * D ** (-0.5)
        off = Sk - Sq
        qi = torch.arange(Sq)[:, None]
        kj = torch.arange(Sk)[None, :]
        cmask = kj <= qi + off
        scores = torch.where(cmask[None, None], scores, -1000000000.0)
        p = _softmax(scores, axis=-1)
        ctx = torch.einsum('bhqk,bhkd->bhqd', p, v)
        return torch.einsum('bhqd,hdm->bqm', ctx, w_o)

    def _B_ref(x, w_gate, w_up, w_down):
        g = _silu(x @ w_gate)
        u = x @ w_up
        return g * u @ w_down
    x = A_x
    mod = (_silu(c) @ w_mod).reshape(c.shape[0], 6, 1, -1)
    sa, ca, ga, sb, cb, gb = (mod[:, 0].clone(), mod[:, 1].clone(), mod[:, 2].clone(), mod[:, 3].clone(), mod[:, 4].clone(), mod[:, 5].clone())
    h = _layernorm(x, axis=-1) * (1 + ca) + sa
    x = x + ga * _A_ref(h, A_c_kv, A_w_q, A_w_uk, A_w_uv, A_w_o)
    h = _layernorm(x, axis=-1) * (1 + cb) + sb
    x = x + gb * _B_ref(h, B_w_gate, B_w_up, B_w_down)
    return x
```

```asm
; @launch grid=(256,1,1) block=(512,1,1) lds=163840
.amdgcn_target "amdgcn-amd-amdhsa--gfx950"
.text
.globl adaLN_cond__compressed_kv_cla__swiglu_ffn__decode_kernel
.p2align 8
.type adaLN_cond__compressed_kv_cla__swiglu_ffn__decode_kernel,@function
adaLN_cond__compressed_kv_cla__swiglu_ffn__decode_kernel:
L_code_start:
    s_getpc_b64 s[6:7]
    s_cmp_ge_u32 s2, 256
    s_cbranch_scc1 L_end
    s_load_dwordx16 s[16:31], s[0:1], 0
    s_load_dwordx8 s[32:39], s[0:1], 64
    s_load_dwordx4 s[40:43], s[0:1], 96
    s_load_dwordx2 s[44:45], s[0:1], 112
    v_and_b32 v1, 63, v0
    v_lshrrev_b32 v24, 6, v0
    v_and_b32 v2, 15, v0
    v_readfirstlane_b32 s3, v24
    v_bfe_u32 v3, v0, 4, 2
    s_cmp_lt_u32 s3, 7
    s_cbranch_scc1 L_nopf
    s_bfe_u32 s5, s2, 0x50003
    s_lshl_b32 s5, s5, 10
    v_lshlrev_b32 v25, 4, v1
    v_add_u32 v25, s5, v25
    v_min_u32 v25, L_code_end-L_code_start-32, v25
    global_load_dwordx4 v[244:247], v25, s[6:7]
L_nopf:
    v_mov_b32 v20, 0
    v_mov_b32 v29, 0
    v_and_b32 v24, 1, v2
    v_lshlrev_b32 v24, 4, v24
    v_mov_b32 v26, 0xffff
    v_lshlrev_b32 v24, v24, v26
    v_bfe_u32 v26, v2, 1, 2
    v_cmp_eq_u32 vcc, 0, v26
    s_nop 1
    v_cndmask_b32 v4, 0, v24, vcc
    v_cmp_eq_u32 vcc, 1, v26
    s_nop 1
    v_cndmask_b32 v5, 0, v24, vcc
    v_cmp_eq_u32 vcc, 2, v26
    s_nop 1
    v_cndmask_b32 v6, 0, v24, vcc
    v_cmp_eq_u32 vcc, 3, v26
    s_nop 1
    v_cndmask_b32 v7, 0, v24, vcc
    s_waitcnt lgkmcnt(0)
    s_load_dword s46, s[44:45], 2048
    s_mov_b32 s48, s44
    s_mov_b32 s49, s45
    s_mov_b32 s50, 268435456
    s_mov_b32 s51, 0x00020000
    s_cmp_ge_u32 s2, 128
    s_cbranch_scc1 L_F
    s_mov_b32 s64, s18
    s_mov_b32 s65, s19
    s_mov_b32 s66, 16777216
    s_mov_b32 s67, 0x00020000
    s_cmp_ge_u32 s2, 80
    s_cbranch_scc1 L_A_hold
    s_and_b32 s47, s2, 63
    s_lshl_b32 s47, s47, 10
    s_add_u32 s47, s47, 189440
    v_lshlrev_b32 v36, 4, v0
    v_mov_b32 v32, -1
    v_mov_b32 v33, -1
    v_mov_b32 v34, -1
    v_mov_b32 v35, -1
    s_mul_i32 s10, s2, 205
    s_lshr_b32 s10, s10, 11
    s_mul_i32 s11, s10, 10
    s_sub_u32 s11, s2, s11
    s_cmp_ge_u32 s3, 5
    s_cbranch_scc1 L_S1_other
    s_mov_b32 s52, s38
    s_mov_b32 s53, s39
    s_mov_b32 s54, 4915200
    s_mov_b32 s55, 0x00020000
    s_mov_b32 s56, s36
    s_mov_b32 s57, s37
    s_mov_b32 s58, 2560
    s_mov_b32 s59, 0x00020000
    s_mul_i32 s12, s10, 80
    s_lshl_b32 s13, s3, 4
    s_add_u32 s12, s12, s13
    v_lshl_add_u32 v24, v3, 2, s12
    v_lshrrev_b32 v25, 3, v2
    v_mul_u32_u24 v26, 1280, v25
    v_lshl_add_u32 v26, v24, 1, v26
    buffer_load_dwordx2 v[28:29], v26, s[56:59], 0 offen
    v_mul_u32_u24 v27, 7680, v24
    v_mul_u32_u24 v26, 1152, v25
    v_lshl_add_u32 v26, v2, 4, v26
    s_lshl_b32 s13, s11, 7
    v_add3_u32 v27, v27, v26, s13
    buffer_load_dwordx4 v[64:67], v27, s[52:55], 0 offen nt
    s_movk_i32 s13, 7680
    buffer_load_dwordx4 v[68:71], v27, s[52:55], s13 offen nt
    s_movk_i32 s13, 15360
    buffer_load_dwordx4 v[72:75], v27, s[52:55], s13 offen nt
    s_movk_i32 s13, 23040
    buffer_load_dwordx4 v[76:79], v27, s[52:55], s13 offen nt
    v_add_u32 v36, 131072, v36
    v_lshrrev_b32 v37, 1, v3
    v_lshlrev_b32 v30, 8, v37
    v_and_b32 v31, 7, v2
    v_lshl_add_u32 v30, v31, 5, v30
    v_and_b32 v24, 1, v3
    v_lshl_add_u32 v30, v24, 4, v30
    v_add_u32 v30, 139264, v30
    v_mul_u32_u24 v37, 2560, v37
    v_lshl_add_u32 v37, v31, 5, v37
    v_lshl_add_u32 v37, v24, 4, v37
    s_mul_i32 s12, s10, 5120
    s_lshl_b32 s13, s11, 8
    s_add_u32 s12, s12, s13
    s_add_u32 s12, s12, 6291456
    s_cmp_eq_u32 s10, 0
    s_cselect_b32 s13, 1.0, 0
    s_mov_b32 s8, 0x00ff00ff
    s_mov_b32 s9, 0x00ff00ff
    s_bfe_u32 s89, s2, 0x20003
    s_lshl_b32 s89, s89, 8
    s_and_b32 s89, s89, 0x300
    s_lshl_b32 s80, s2, 7
    s_lshl_b32 s81, s3, 4
    s_add_u32 s80, s80, s81
    s_lshl_b32 s80, s80, 10
    s_lshl_b32 s81, s3, 12
    v_lshlrev_b32 v240, 2, v3
    v_xor_b32 v240, v240, v2
    v_lshlrev_b32 v240, 4, v240
    v_lshl_add_u32 v240, v3, 10, v240
    v_xor_b32 v241, 16, v240
    v_add_u32 v241, 3072, v241
    v_xor_b32 v242, 32, v240
    v_add_u32 v242, 6144, v242
    v_xor_b32 v243, 48, v240
    v_add_u32 v243, 9216, v243
    s_waitcnt vmcnt(4)
    v_lshlrev_b32 v16, 16, v28
    v_and_b32 v17, 0xffff0000, v28
    v_lshlrev_b32 v18, 16, v29
    v_and_b32 v19, 0xffff0000, v29
    v_mul_f32 v24, 0xbfb8aa3b, v16
    v_exp_f32 v24, v24
    s_nop 0
    v_add_f32 v24, 1.0, v24
    v_rcp_f32 v24, v24
    s_nop 0
    v_mul_f32 v16, v16, v24
    v_mul_f32 v24, 0xbfb8aa3b, v17
    v_exp_f32 v24, v24
    s_nop 0
    v_add_f32 v24, 1.0, v24
    v_rcp_f32 v24, v24
    s_nop 0
    v_mul_f32 v17, v17, v24
    v_mul_f32 v24, 0xbfb8aa3b, v18
    v_exp_f32 v24, v24
    s_nop 0
    v_add_f32 v24, 1.0, v24
    v_rcp_f32 v24, v24
    s_nop 0
    v_mul_f32 v18, v18, v24
    v_mul_f32 v24, 0xbfb8aa3b, v19
    v_exp_f32 v24, v24
    s_nop 0
    v_add_f32 v24, 1.0, v24
    v_rcp_f32 v24, v24
    s_nop 0
    v_mul_f32 v19, v19, v24
    v_cvt_pk_bf16_f32 v16, v16, v16
    v_cvt_pk_bf16_f32 v17, v17, v17
    v_cvt_pk_bf16_f32 v18, v18, v18
    v_cvt_pk_bf16_f32 v19, v19, v19
    v_and_b32 v8, v16, v4
    v_and_b32 v9, v16, v5
    v_and_b32 v10, v16, v6
    v_and_b32 v11, v16, v7
    v_and_b32 v12, v17, v4
    v_and_b32 v13, v17, v5
    v_and_b32 v14, v17, v6
    v_and_b32 v15, v17, v7
    s_waitcnt vmcnt(3)
    v_mfma_f32_16x16x32_bf16 v[40:43], v[8:11], v[64:67], 0
    v_and_b32 v8, v18, v4
    v_and_b32 v9, v18, v5
    v_and_b32 v10, v18, v6
    v_and_b32 v11, v18, v7
    s_waitcnt vmcnt(2)
    v_mfma_f32_16x16x32_bf16 v[40:43], v[12:15], v[68:71], v[40:43]
    v_and_b32 v12, v19, v4
    v_and_b32 v13, v19, v5
    v_and_b32 v14, v19, v6
    v_and_b32 v15, v19, v7
    s_waitcnt vmcnt(1)
    v_mfma_f32_16x16x32_bf16 v[40:43], v[8:11], v[72:75], v[40:43]
    s_nop 1
    s_waitcnt vmcnt(0)
    v_mfma_f32_16x16x32_bf16 v[40:43], v[12:15], v[76:79], v[40:43]
    s_nop 7
    ds_write_b128 v36, v[40:43]
    s_waitcnt lgkmcnt(0)
    s_mul_i32 s4, s46, 1664525
    s_add_u32 s4, s4, 1013904223
    s_waitcnt vmcnt(0)
    s_barrier
    s_cmp_lg_u32 s3, 0
    s_cbranch_scc1 L_S1_end
    ds_read_b128 v[44:47], v30
    v_mov_b32 v53, s4
    v_mov_b32 v55, s4
    ds_read_b128 v[64:67], v36 offset:0
    ds_read_b128 v[68:71], v36 offset:1024
    ds_read_b128 v[72:75], v36 offset:2048
    ds_read_b128 v[76:79], v36 offset:3072
    ds_read_b128 v[80:83], v36 offset:4096
    s_waitcnt lgkmcnt(3)
    v_pk_add_f32 v[64:65], v[64:65], v[68:69]
    v_pk_add_f32 v[66:67], v[66:67], v[70:71]
    s_waitcnt lgkmcnt(2)
    v_pk_add_f32 v[64:65], v[64:65], v[72:73]
    v_pk_add_f32 v[66:67], v[66:67], v[74:75]
    s_waitcnt lgkmcnt(1)
    v_pk_add_f32 v[64:65], v[64:65], v[76:77]
    v_pk_add_f32 v[66:67], v[66:67], v[78:79]
    s_waitcnt lgkmcnt(0)
    v_pk_add_f32 v[40:41], v[64:65], v[80:81]
    v_pk_add_f32 v[42:43], v[66:67], v[82:83]
    s_nop 1
    v_mov_b32_dpp v48, v40 row_ror:8 row_mask:0xf bank_mask:0xf
    v_mov_b32_dpp v49, v41 row_ror:8 row_mask:0xf bank_mask:0xf
    v_mov_b32_dpp v50, v42 row_ror:8 row_mask:0xf bank_mask:0xf
    v_mov_b32_dpp v51, v43 row_ror:8 row_mask:0xf bank_mask:0xf
    v_add_f32 v48, s13, v48
    v_add_f32 v49, s13, v49
    v_add_f32 v50, s13, v50
    v_add_f32 v51, s13, v51
    v_fmac_f32 v40, v44, v48
    v_fmac_f32 v41, v45, v49
    v_fmac_f32 v42, v46, v50
    v_fmac_f32 v43, v47, v51
    v_cvt_pk_bf16_f32 v52, v40, v41
    v_cvt_pk_bf16_f32 v54, v42, v43
    s_mov_b64 exec, s[8:9]
    buffer_store_dwordx4 v[52:55], v37, s[48:51], s12 offen sc1
    s_add_u32 s12, s12, 40960
    buffer_store_dwordx4 v[52:55], v37, s[48:51], s12 offen sc1
    s_add_u32 s12, s12, 40960
    buffer_store_dwordx4 v[52:55], v37, s[48:51], s12 offen sc1
    s_add_u32 s12, s12, 40960
    buffer_store_dwordx4 v[52:55], v37, s[48:51], s12 offen sc1
    s_mov_b64 exec, -1
    s_branch L_S1_end
L_S1_other:
    s_cmp_eq_u32 s3, 7
    s_cbranch_scc1 L_S1_w7
    s_mov_b32 s60, s16
    s_mov_b32 s61, s17
    s_mov_b32 s62, 2560
    s_mov_b32 s63, 0x00020000
    s_sub_u32 s12, s3, 5
    s_mul_i32 s13, s12, 1280
    v_lshlrev_b32 v24, 2, v1
    buffer_load_dword v52, v24, s[60:63], s13 offen
    buffer_load_dword v53, v24, s[60:63], s13 offen offset:256
    buffer_load_dword v54, v24, s[60:63], s13 offen offset:512
    buffer_load_dword v55, v24, s[60:63], s13 offen offset:768
    buffer_load_dword v56, v24, s[60:63], s13 offen offset:1024
    s_lshl_b32 s14, s11, 7
    s_add_u32 s13, s13, s14
    v_lshlrev_b32 v25, 1, v1
    buffer_load_ushort v37, v25, s[60:63], s13 offen
    s_bfe_u32 s89, s2, 0x20003
    s_lshl_b32 s89, s89, 8
    s_and_b32 s89, s89, 0x300
    s_lshl_b32 s80, s2, 7
    s_lshl_b32 s81, s3, 4
    s_add_u32 s80, s80, s81
    s_lshl_b32 s80, s80, 10
    s_lshl_b32 s81, s3, 12
    v_lshlrev_b32 v240, 2, v3
    v_xor_b32 v240, v240, v2
    v_lshlrev_b32 v240, 4, v240
    v_lshl_add_u32 v240, v3, 10, v240
    v_xor_b32 v241, 16, v240
    v_add_u32 v241, 3072, v241
    v_xor_b32 v242, 32, v240
    v_add_u32 v242, 6144, v242
    v_xor_b32 v243, 48, v240
    v_add_u32 v243, 9216, v243
    s_waitcnt vmcnt(0)
    v_lshlrev_b32 v40, 16, v52
    v_and_b32 v41, 0xffff0000, v52
    v_lshlrev_b32 v42, 16, v53
    v_and_b32 v43, 0xffff0000, v53
    v_lshlrev_b32 v44, 16, v54
    v_and_b32 v45, 0xffff0000, v54
    v_lshlrev_b32 v46, 16, v55
    v_and_b32 v47, 0xffff0000, v55
    v_lshlrev_b32 v48, 16, v56
    v_and_b32 v49, 0xffff0000, v56
    v_add_f32 v26, v40, v41
    v_add_f32 v26, v26, v42
    v_add_f32 v26, v26, v43
    v_add_f32 v26, v26, v44
    v_add_f32 v26, v26, v45
    v_add_f32 v26, v26, v46
    v_add_f32 v26, v26, v47
    v_add_f32 v26, v26, v48
    v_add_f32 v26, v26, v49
    s_nop 1
    v_add_f32_dpp v26, v26, v26 row_ror:8 row_mask:0xf bank_mask:0xf
    s_nop 1
    v_add_f32_dpp v26, v26, v26 row_ror:4 row_mask:0xf bank_mask:0xf
    s_nop 1
    v_add_f32_dpp v26, v26, v26 row_ror:2 row_mask:0xf bank_mask:0xf
    s_nop 1
    v_add_f32_dpp v26, v26, v26 row_ror:1 row_mask:0xf bank_mask:0xf
    v_mov_b32 v27, v26
    s_nop 1
    v_permlane16_swap_b32 v26, v27
    s_nop 1
    v_add_f32 v26, v26, v27
    v_mov_b32 v27, v26
    s_nop 1
    v_permlane32_swap_b32 v26, v27
    s_nop 1
    v_add_f32 v26, v26, v27
    v_mul_f32 v26, 0x3acccccd, v26
    v_sub_f32 v40, v40, v26
    v_mul_f32 v28, v40, v40
    v_sub_f32 v41, v41, v26
    v_fmac_f32 v28, v41, v41
    v_sub_f32 v42, v42, v26
    v_fmac_f32 v28, v42, v42
    v_sub_f32 v43, v43, v26
    v_fmac_f32 v28, v43, v43
    v_sub_f32 v44, v44, v26
    v_fmac_f32 v28, v44, v44
    v_sub_f32 v45, v45, v26
    v_fmac_f32 v28, v45, v45
    v_sub_f32 v46, v46, v26
    v_fmac_f32 v28, v46, v46
    v_sub_f32 v47, v47, v26
    v_fmac_f32 v28, v47, v47
    v_sub_f32 v48, v48, v26
    v_fmac_f32 v28, v48, v48
    v_sub_f32 v49, v49, v26
    v_fmac_f32 v28, v49, v49
    s_nop 1
    v_add_f32_dpp v28, v28, v28 row_ror:8 row_mask:0xf bank_mask:0xf
    s_nop 1
    v_add_f32_dpp v28, v28, v28 row_ror:4 row_mask:0xf bank_mask:0xf
    s_nop 1
    v_add_f32_dpp v28, v28, v28 row_ror:2 row_mask:0xf bank_mask:0xf
    s_nop 1
    v_add_f32_dpp v28, v28, v28 row_ror:1 row_mask:0xf bank_mask:0xf
    v_mov_b32 v27, v28
    s_nop 1
    v_permlane16_swap_b32 v28, v27
    s_nop 1
    v_add_f32 v28, v28, v27
    v_mov_b32 v27, v28
    s_nop 1
    v_permlane32_swap_b32 v28, v27
    s_nop 1
    v_add_f32 v28, v28, v27
    v_mov_b32 v27, 0x3727c5ac
    v_fmac_f32 v27, 0x3acccccd, v28
    v_rsq_f32 v27, v27
    v_lshlrev_b32 v37, 16, v37
    v_sub_f32 v37, v37, v26
    v_mul_f32 v37, v37, v27
    s_lshl_b32 s12, s12, 8
    s_add_u32 s12, s12, 139264
    v_add_u32 v24, s12, v24
    ds_write_b32 v24, v37
    s_branch L_S1_bar
L_S1_w7:
    buffer_store_dwordx4 v[32:35], v36, s[48:51], s47 offen sc1
    s_bfe_u32 s89, s2, 0x20003
    s_lshl_b32 s89, s89, 8
    s_and_b32 s89, s89, 0x300
    s_lshl_b32 s80, s2, 7
    s_lshl_b32 s81, s3, 4
    s_add_u32 s80, s80, s81
    s_lshl_b32 s80, s80, 10
    s_lshl_b32 s81, s3, 12
    v_lshlrev_b32 v240, 2, v3
    v_xor_b32 v240, v240, v2
    v_lshlrev_b32 v240, 4, v240
    v_lshl_add_u32 v240, v3, 10, v240
    v_xor_b32 v241, 16, v240
    v_add_u32 v241, 3072, v241
    v_xor_b32 v242, 32, v240
    v_add_u32 v242, 6144, v242
    v_xor_b32 v243, 48, v240
    v_add_u32 v243, 9216, v243
L_S1_bar:
    s_waitcnt vmcnt(0) lgkmcnt(0)
    s_barrier
L_S1_end:
    s_barrier
    s_branch L_A_main
L_A_hold:
    s_bfe_u32 s89, s2, 0x20003
    s_lshl_b32 s89, s89, 8
    s_and_b32 s89, s89, 0x300
    s_lshl_b32 s80, s2, 7
    s_lshl_b32 s81, s3, 4
    s_add_u32 s80, s80, s81
    s_lshl_b32 s80, s80, 10
    s_lshl_b32 s81, s3, 12
    v_lshlrev_b32 v240, 2, v3
    v_xor_b32 v240, v240, v2
    v_lshlrev_b32 v240, 4, v240
    v_lshl_add_u32 v240, v3, 10, v240
    v_xor_b32 v241, 16, v240
    v_add_u32 v241, 3072, v241
    v_xor_b32 v242, 32, v240
    v_add_u32 v242, 6144, v242
    v_xor_b32 v243, 48, v240
    v_add_u32 v243, 9216, v243
    s_waitcnt lgkmcnt(0)
    s_mul_i32 s4, s46, 1664525
    s_add_u32 s4, s4, 1013904223
    s_cmp_lg_u32 s3, 0
    s_cbranch_scc1 L_hold_x
    s_sub_u32 s12, s2, 80
    s_lshl_b32 s12, s12, 9
    s_add_u32 s12, s12, 6291460
    v_mov_b32 v26, s12
    s_mov_b64 exec, 1
    buffer_load_dword v27, v26, s[48:51], 0 offen sc1
    s_waitcnt vmcnt(0)
    v_cmp_ne_u32 vcc, s4, v27
    s_cbranch_vccz L_hold_x
L_hold_x:
    s_mov_b64 exec, -1
    s_barrier
L_A_main:
    s_mov_b32 s56, s24
    s_mov_b32 s57, s25
    s_mov_b32 s58, 4194304
    s_mov_b32 s59, 0x00020000
    s_lshr_b32 s10, s2, 6
    s_and_b32 s11, s2, 63
    v_and_b32 v24, 31, v1
    v_lshrrev_b32 v25, 5, v1
    v_lshlrev_b32 v26, 4, v1
    s_lshl_b32 s13, s2, 8
    s_add_u32 s13, s13, 1048576
    v_lshrrev_b32 v23, 3, v1
    v_mul_u32_u24 v23, 132096, v23
    v_and_b32 v27, 7, v1
    v_lshl_add_u32 v23, v27, 4, v23
    s_and_b32 s12, s3, 3
    s_lshr_b32 s14, s89, 8
    s_xor_b32 s12, s12, s14
    s_mul_i32 s12, s12, 33024
    s_add_u32 s68, s12, s13
    s_add_u32 s69, s68, 1056768
    s_add_u32 s70, s68, 2113536
    s_add_u32 s71, s68, 3170304
    v_and_b32 v22, 3, v1
    v_lshlrev_b32 v22, 10, v22
    s_and_b32 s9, s2, 31
    s_lshl_b32 s9, s9, 12
    s_lshl_b32 s14, s3, 7
    s_add_u32 s9, s9, s14
    s_add_u32 s9, s9, 65536
    s_add_u32 s82, s81, 0
    s_mov_b32 m0, s82
    s_xor_b32 s83, s89, 0
    s_add_u32 s83, s80, s83
    buffer_load_dwordx4 v240, s[64:67], s83 offen offset:0 nt lds
    buffer_load_dwordx4 v241, s[64:67], s83 offen offset:1024 nt lds
    buffer_load_dwordx4 v242, s[64:67], s83 offen offset:2048 nt lds
    buffer_load_dwordx4 v243, s[64:67], s83 offen offset:3072 nt lds
    s_add_u32 s82, s81, 32768
    s_mov_b32 m0, s82
    s_xor_b32 s83, s89, 256
    s_add_u32 s83, s80, s83
    buffer_load_dwordx4 v240, s[64:67], s83 offen offset:0 nt lds
    buffer_load_dwordx4 v241, s[64:67], s83 offen offset:1024 nt lds
    buffer_load_dwordx4 v242, s[64:67], s83 offen offset:2048 nt lds
    buffer_load_dwordx4 v243, s[64:67], s83 offen offset:3072 nt lds
    s_add_u32 s82, s81, 65536
    s_mov_b32 m0, s82
    s_xor_b32 s83, s89, 512
    s_add_u32 s83, s80, s83
    buffer_load_dwordx4 v240, s[64:67], s83 offen offset:0 nt lds
    buffer_load_dwordx4 v241, s[64:67], s83 offen offset:1024 nt lds
    buffer_load_dwordx4 v242, s[64:67], s83 offen offset:2048 nt lds
    buffer_load_dwordx4 v243, s[64:67], s83 offen offset:3072 nt lds
    buffer_load_dword v21, v22, s[48:51], s9 offen offset:4 sc1
    s_add_u32 s82, s81, 98304
    s_mov_b32 m0, s82
    s_xor_b32 s83, s89, 768
    s_add_u32 s83, s80, s83
    buffer_load_dwordx4 v240, s[64:67], s83 offen offset:0 nt lds
    buffer_load_dwordx4 v241, s[64:67], s83 offen offset:1024 nt lds
    buffer_load_dwordx4 v242, s[64:67], s83 offen offset:2048 nt lds
    buffer_load_dwordx4 v243, s[64:67], s83 offen offset:3072 nt lds
    s_waitcnt lgkmcnt(0)
    s_mul_i32 s4, s46, 1664525
    s_add_u32 s4, s4, 1013904223
    v_and_b32 v27, 7, v1
    v_mul_u32_u24 v27, 37, v27
    v_xor_b32 v27, s4, v27
    s_mov_b32 s79, 0x00010001
    v_bfe_u32 v28, v27, 0, 1
    v_bfe_u32 v29, v27, 1, 1
    v_lshl_or_b32 v248, v29, 16, v28
    v_bfe_u32 v28, v27, 2, 1
    v_bfe_u32 v29, v27, 3, 1
    v_lshl_or_b32 v249, v29, 16, v28
    v_bfe_u32 v28, v27, 4, 1
    v_bfe_u32 v29, v27, 5, 1
    v_lshl_or_b32 v250, v29, 16, v28
    v_bfe_u32 v28, v27, 6, 1
    v_bfe_u32 v29, v27, 7, 1
    v_lshl_or_b32 v251, v29, 16, v28
    s_and_b32 s72, s2, 7
    s_lshl_b32 s72, s72, 2
    s_bfe_u32 s73, s2, 0x20003
    s_add_u32 s72, s72, s73
    s_lshr_b32 s73, s2, 5
    s_lshl_b32 s74, s72, 2
    s_add_u32 s74, s74, s73
    s_lshl_b32 s76, s10, 5
    s_lshl_b32 s13, s3, 2
    s_add_u32 s76, s76, s13
    s_lshl_b32 s76, s76, 10
    s_add_u32 s76, s76, 196608
    s_lshl_b32 s77, s13, 10
    s_add_u32 s77, s77, 131072
    s_and_b32 s14, s3, 3
    v_xor_b32 v16, s14, v1
    v_lshlrev_b32 v16, 4, v16
    v_xor_b32 v16, s89, v16
    v_xor_b32 v17, 64, v16
    v_xor_b32 v18, 128, v16
    v_xor_b32 v19, 192, v16
    v_add_u32 v31, s77, v26
    s_cmp_ge_u32 s3, 4
    s_cbranch_scc1 L_A_pvprep
    s_lshl_b32 s8, s73, 7
    s_lshl_b32 s13, s3, 5
    s_add_u32 s8, s8, s13
    v_lshl_add_u32 v20, v3, 2, s8
    v_lshlrev_b32 v20, 13, v20
    v_lshl_add_u32 v20, v2, 4, v20
    s_lshl_b32 s75, s72, 8
    v_and_b32 v27, 3, v1
    v_lshlrev_b32 v27, 2, v27
    v_bfe_u32 v28, v1, 2, 2
    v_or_b32 v27, v27, v28
    v_xor_b32 v27, v27, v25
    v_lshlrev_b32 v27, 4, v27
    v_lshl_or_b32 v28, v24, 10, v27
    v_lshl_or_b32 v27, v24, 8, v27
    s_lshl_b32 s12, s3, 13
    v_add_u32 v27, s12, v27
    v_add_u32 v28, 131072, v28
    v_xor_b32 v224, 0, v27
    v_xor_b32 v232, 0, v28
    v_xor_b32 v225, 32, v27
    v_xor_b32 v233, 32, v28
    v_xor_b32 v226, 64, v27
    v_xor_b32 v234, 64, v28
    v_xor_b32 v227, 96, v27
    v_xor_b32 v235, 96, v28
    v_xor_b32 v228, 128, v27
    v_xor_b32 v236, 128, v28
    v_xor_b32 v229, 160, v27
    v_xor_b32 v237, 160, v28
    v_xor_b32 v230, 192, v27
    v_xor_b32 v238, 192, v28
    v_xor_b32 v231, 224, v27
    v_xor_b32 v239, 224, v28
    s_waitcnt vmcnt(13) lgkmcnt(0)
    s_barrier
    ds_read_b128 v[32:35], v224 offset:0
    ds_read_b128 v[36:39], v225 offset:0
    ds_read_b128 v[40:43], v226 offset:0
    ds_read_b128 v[44:47], v227 offset:0
    ds_read_b128 v[48:51], v228 offset:0
    ds_read_b128 v[52:55], v229 offset:0
    ds_read_b128 v[56:59], v230 offset:0
    ds_read_b128 v[60:63], v231 offset:0
    s_waitcnt vmcnt(9) lgkmcnt(0)
    s_barrier
    ds_read_b128 v[64:67], v224 offset:32768
    ds_read_b128 v[68:71], v225 offset:32768
    ds_read_b128 v[72:75], v226 offset:32768
    ds_read_b128 v[76:79], v227 offset:32768
    ds_read_b128 v[80:83], v228 offset:32768
    ds_read_b128 v[84:87], v229 offset:32768
    ds_read_b128 v[88:91], v230 offset:32768
    ds_read_b128 v[92:95], v231 offset:32768
    s_waitcnt vmcnt(4) lgkmcnt(0)
    v_cmp_ne_u32 vcc, s4, v21
    s_mov_b32 s78, 0
    s_cbranch_vccnz L_qi0
    s_mov_b32 m0, s77
    s_mov_b32 s78, 1
    buffer_load_dwordx4 v16, s[48:51], s76 offen offset:0 sc1 lds
    buffer_load_dwordx4 v17, s[48:51], s76 offen offset:1024 sc1 lds
    buffer_load_dwordx4 v18, s[48:51], s76 offen offset:2048 sc1 lds
    buffer_load_dwordx4 v19, s[48:51], s76 offen offset:3072 sc1 lds
L_qi0:
    s_barrier
    v_add_u32 v224, 0x10000, v224
    v_add_u32 v225, 0x10000, v225
    v_add_u32 v226, 0x10000, v226
    v_add_u32 v227, 0x10000, v227
    v_add_u32 v228, 0x10000, v228
    v_add_u32 v229, 0x10000, v229
    v_add_u32 v230, 0x10000, v230
    v_add_u32 v231, 0x10000, v231
    ds_read_b128 v[96:99], v224 offset:0
    ds_read_b128 v[100:103], v225 offset:0
    ds_read_b128 v[104:107], v226 offset:0
    ds_read_b128 v[108:111], v227 offset:0
    ds_read_b128 v[112:115], v228 offset:0
    ds_read_b128 v[116:119], v229 offset:0
    ds_read_b128 v[120:123], v230 offset:0
    ds_read_b128 v[124:127], v231 offset:0
    s_cmp_eq_u32 s78, 1
    s_cbranch_scc1 L_qw0
    s_waitcnt vmcnt(0)
L_qw0:
    s_waitcnt vmcnt(4) lgkmcnt(0)
    s_barrier
    ds_read_b128 v[128:131], v224 offset:32768
    ds_read_b128 v[132:135], v225 offset:32768
    ds_read_b128 v[136:139], v226 offset:32768
    ds_read_b128 v[140:143], v227 offset:32768
    ds_read_b128 v[144:147], v228 offset:32768
    ds_read_b128 v[148:151], v229 offset:32768
    ds_read_b128 v[152:155], v230 offset:32768
    ds_read_b128 v[156:159], v231 offset:32768
    s_branch L_A_q
L_A_pvprep:
    v_lshrrev_b32 v27, 2, v2
    v_lshrrev_b32 v28, 1, v3
    v_and_b32 v29, 1, v3
    v_lshl_add_u32 v30, v28, 3, v27
    v_lshlrev_b32 v30, 8, v30
    v_bfe_u32 v20, v2, 1, 1
    v_lshl_add_u32 v20, v29, 1, v20
    v_lshlrev_b32 v27, 2, v27
    v_lshl_or_b32 v27, v28, 1, v27
    v_xor_b32 v20, v20, v27
    v_lshlrev_b32 v20, 4, v20
    v_and_b32 v27, 1, v2
    v_lshlrev_b32 v27, 3, v27
    v_add3_u32 v30, v30, v20, v27
    s_and_b32 s12, s3, 3
    s_lshl_b32 s13, s12, 15
    v_add_u32 v30, s13, v30
    s_lshl_b32 s14, s2, 6
    s_add_u32 s14, s14, 1015808
    v_mov_b32 v28, s4
    v_mov_b32 v29, s14
    v_xor_b32 v224, 0, v30
    v_xor_b32 v225, 1040, v30
    v_xor_b32 v226, 64, v30
    v_xor_b32 v227, 1104, v30
    v_xor_b32 v228, 128, v30
    v_xor_b32 v229, 1168, v30
    v_xor_b32 v230, 192, v30
    v_xor_b32 v231, 1232, v30
    s_waitcnt vmcnt(13) lgkmcnt(0)
    s_barrier
    s_cmp_lg_u32 s12, 0
    s_cbranch_scc1 L_trs0
L_trread:
    ds_read_b64_tr_b16 v[32:33], v224 offset:0
    ds_read_b64_tr_b16 v[34:35], v225 offset:0
    ds_read_b64_tr_b16 v[36:37], v224 offset:4096
    ds_read_b64_tr_b16 v[38:39], v225 offset:4096
    ds_read_b64_tr_b16 v[40:41], v224 offset:8192
    ds_read_b64_tr_b16 v[42:43], v225 offset:8192
    ds_read_b64_tr_b16 v[44:45], v224 offset:12288
    ds_read_b64_tr_b16 v[46:47], v225 offset:12288
    ds_read_b64_tr_b16 v[48:49], v224 offset:16384
    ds_read_b64_tr_b16 v[50:51], v225 offset:16384
    ds_read_b64_tr_b16 v[52:53], v224 offset:20480
    ds_read_b64_tr_b16 v[54:55], v225 offset:20480
    ds_read_b64_tr_b16 v[56:57], v224 offset:24576
    ds_read_b64_tr_b16 v[58:59], v225 offset:24576
    ds_read_b64_tr_b16 v[60:61], v224 offset:28672
    ds_read_b64_tr_b16 v[62:63], v225 offset:28672
    ds_read_b64_tr_b16 v[64:65], v226 offset:0
    ds_read_b64_tr_b16 v[66:67], v227 offset:0
    ds_read_b64_tr_b16 v[68:69], v226 offset:4096
    ds_read_b64_tr_b16 v[70:71], v227 offset:4096
    ds_read_b64_tr_b16 v[72:73], v226 offset:8192
    ds_read_b64_tr_b16 v[74:75], v227 offset:8192
    ds_read_b64_tr_b16 v[76:77], v226 offset:12288
    ds_read_b64_tr_b16 v[78:79], v227 offset:12288
    ds_read_b64_tr_b16 v[80:81], v226 offset:16384
    ds_read_b64_tr_b16 v[82:83], v227 offset:16384
    ds_read_b64_tr_b16 v[84:85], v226 offset:20480
    ds_read_b64_tr_b16 v[86:87], v227 offset:20480
    ds_read_b64_tr_b16 v[88:89], v226 offset:24576
    ds_read_b64_tr_b16 v[90:91], v227 offset:24576
    ds_read_b64_tr_b16 v[92:93], v226 offset:28672
    ds_read_b64_tr_b16 v[94:95], v227 offset:28672
    ds_read_b64_tr_b16 v[96:97], v228 offset:0
    ds_read_b64_tr_b16 v[98:99], v229 offset:0
    ds_read_b64_tr_b16 v[100:101], v228 offset:4096
    ds_read_b64_tr_b16 v[102:103], v229 offset:4096
    ds_read_b64_tr_b16 v[104:105], v228 offset:8192
    ds_read_b64_tr_b16 v[106:107], v229 offset:8192
    ds_read_b64_tr_b16 v[108:109], v228 offset:12288
    ds_read_b64_tr_b16 v[110:111], v229 offset:12288
    ds_read_b64_tr_b16 v[112:113], v228 offset:16384
    ds_read_b64_tr_b16 v[114:115], v229 offset:16384
    ds_read_b64_tr_b16 v[116:117], v228 offset:20480
    ds_read_b64_tr_b16 v[118:119], v229 offset:20480
    ds_read_b64_tr_b16 v[120:121], v228 offset:24576
    ds_read_b64_tr_b16 v[122:123], v229 offset:24576
    ds_read_b64_tr_b16 v[124:125], v228 offset:28672
    ds_read_b64_tr_b16 v[126:127], v229 offset:28672
    ds_read_b64_tr_b16 v[128:129], v230 offset:0
    ds_read_b64_tr_b16 v[130:131], v231 offset:0
    ds_read_b64_tr_b16 v[132:133], v230 offset:4096
    ds_read_b64_tr_b16 v[134:135], v231 offset:4096
    ds_read_b64_tr_b16 v[136:137], v230 offset:8192
    ds_read_b64_tr_b16 v[138:139], v231 offset:8192
    ds_read_b64_tr_b16 v[140:141], v230 offset:12288
    ds_read_b64_tr_b16 v[142:143], v231 offset:12288
    ds_read_b64_tr_b16 v[144:145], v230 offset:16384
    ds_read_b64_tr_b16 v[146:147], v231 offset:16384
    ds_read_b64_tr_b16 v[148:149], v230 offset:20480
    ds_read_b64_tr_b16 v[150:151], v231 offset:20480
    ds_read_b64_tr_b16 v[152:153], v230 offset:24576
    ds_read_b64_tr_b16 v[154:155], v231 offset:24576
    ds_read_b64_tr_b16 v[156:157], v230 offset:28672
    ds_read_b64_tr_b16 v[158:159], v231 offset:28672
    s_cmp_eq_u32 s12, 1
    s_cbranch_scc1 L_trs1
    s_cmp_eq_u32 s12, 2
    s_cbranch_scc1 L_trs2
    s_cmp_eq_u32 s12, 3
    s_cbranch_scc1 L_trs3
L_trs0:
    s_waitcnt vmcnt(9) lgkmcnt(0)
    s_barrier
    s_cmp_lg_u32 s12, 1
    s_cbranch_scc1 L_trs1
    s_branch L_trread
L_trs1:
    s_waitcnt vmcnt(4) lgkmcnt(0)
    v_cmp_ne_u32 vcc, s4, v21
    s_mov_b32 s78, 0
    s_cbranch_vccnz L_qi1
    s_mov_b32 m0, s77
    s_mov_b32 s78, 1
    buffer_load_dwordx4 v16, s[48:51], s76 offen offset:0 sc1 lds
    buffer_load_dwordx4 v17, s[48:51], s76 offen offset:1024 sc1 lds
    buffer_load_dwordx4 v18, s[48:51], s76 offen offset:2048 sc1 lds
    buffer_load_dwordx4 v19, s[48:51], s76 offen offset:3072 sc1 lds
L_qi1:
    s_barrier
    s_cmp_lg_u32 s3, 7
    s_cbranch_scc1 L_notrig
    s_mov_b64 exec, 1
    buffer_store_dword v28, v29, s[48:51], 0 offen sc1
    s_mov_b64 exec, -1
L_notrig:
    s_cmp_lg_u32 s12, 2
    s_cbranch_scc1 L_trs2
    s_branch L_trread
L_trs2:
    s_cmp_eq_u32 s78, 1
    s_cbranch_scc1 L_qw1
    s_waitcnt vmcnt(0)
L_qw1:
    s_waitcnt vmcnt(4) lgkmcnt(0)
    s_barrier
    s_cmp_lg_u32 s12, 3
    s_cbranch_scc1 L_trs3
    s_branch L_trread
L_trs3:
L_A_q:
    s_cmp_eq_u32 s78, 1
    s_mov_b32 s5, 0
    s_cbranch_scc1 L_Qdma_w
    s_mov_b64 exec, 15
    s_mov_b32 s5, 0
    s_branch L_wit_l
L_wit:
    s_sleep 2
L_wit_l:
    buffer_load_dword v21, v22, s[48:51], s9 offen offset:4 sc1
    s_waitcnt vmcnt(0)
L_wit_c:
    s_add_u32 s5, s5, 1
    s_cmp_gt_u32 s5, 200000
    s_cbranch_scc1 L_wit_x
    v_cmp_ne_u32 vcc, s4, v21
    s_mov_b64 exec, vcc
    s_cbranch_execnz L_wit
L_wit_x:
    s_mov_b64 exec, -1
    s_lshl_b32 s14, s11, 6
    v_mov_b32 v22, s14
    s_mov_b64 exec, 1
    s_mov_b32 s5, 0
    buffer_load_dword v244, v22, s[48:51], s76 offen offset:60 sc1
    s_sleep 3
    buffer_load_dword v245, v22, s[48:51], s76 offen offset:60 sc1
    s_sleep 3
    buffer_load_dword v246, v22, s[48:51], s76 offen offset:60 sc1
L_Qgate:
    s_waitcnt vmcnt(2)
    v_cmp_eq_u32 vcc, -1, v244
    s_cbranch_vccz L_Qgate_d0
    buffer_load_dword v244, v22, s[48:51], s76 offen offset:60 sc1
    s_waitcnt vmcnt(2)
    v_cmp_eq_u32 vcc, -1, v245
    s_cbranch_vccz L_Qgate_d1
    buffer_load_dword v245, v22, s[48:51], s76 offen offset:60 sc1
    s_waitcnt vmcnt(2)
    v_cmp_eq_u32 vcc, -1, v246
    s_cbranch_vccz L_Qgate_d2
    buffer_load_dword v246, v22, s[48:51], s76 offen offset:60 sc1
    s_add_u32 s5, s5, 1
    s_cmp_lt_u32 s5, 100000
    s_cbranch_scc1 L_Qgate
L_Qgate_d0:
    s_branch L_Qgate_x
L_Qgate_d1:
    s_branch L_Qgate_x
L_Qgate_d2:
L_Qgate_x:
    s_mov_b64 exec, -1
    s_mov_b32 s5, 0
    s_mov_b32 m0, s77
    s_nop 0
    buffer_load_dwordx4 v16, s[48:51], s76 offen offset:0 sc1 lds
    buffer_load_dwordx4 v17, s[48:51], s76 offen offset:1024 sc1 lds
    buffer_load_dwordx4 v18, s[48:51], s76 offen offset:2048 sc1 lds
    buffer_load_dwordx4 v19, s[48:51], s76 offen offset:3072 sc1 lds
    s_branch L_Qdma_w
L_Qdma:
    s_sleep 2
L_Qdma_l:
    buffer_load_dwordx4 v16, s[48:51], s76 offen offset:0 sc1 lds
    buffer_load_dwordx4 v17, s[48:51], s76 offen offset:1024 sc1 lds
    buffer_load_dwordx4 v18, s[48:51], s76 offen offset:2048 sc1 lds
    buffer_load_dwordx4 v19, s[48:51], s76 offen offset:3072 sc1 lds
L_Qdma_w:
    s_waitcnt vmcnt(0)
    ds_read_b128 v[176:179], v31 offset:0
    ds_read_b128 v[180:183], v31 offset:1024
    ds_read_b128 v[184:187], v31 offset:2048
    ds_read_b128 v[188:191], v31 offset:3072
    s_waitcnt lgkmcnt(0)
    v_max3_u32 v21, v176, v177, v178
    v_max3_u32 v21, v21, v179, v180
    v_max3_u32 v21, v21, v181, v182
    v_max3_u32 v21, v21, v183, v184
    v_max3_u32 v21, v21, v185, v186
    v_max3_u32 v21, v21, v187, v188
    v_max3_u32 v21, v21, v189, v190
    v_max_u32 v21, v21, v191
    s_add_u32 s5, s5, 1
    s_cmp_gt_u32 s5, 200000
    s_cbranch_scc1 L_Qdma_x
    v_cmp_eq_u32 vcc, -1, v21
    s_mov_b64 exec, vcc
    s_cbranch_execnz L_Qdma
L_Qdma_x:
    s_mov_b64 exec, -1
    s_barrier
    s_cmp_lg_u32 s3, 7
    s_cbranch_scc1 L_nofl3
    s_mov_b64 exec, 1
    buffer_store_dword v28, v29, s[48:51], 0 offen offset:32 sc1
    s_mov_b64 exec, -1
L_nofl3:
    s_cmp_ge_u32 s3, 4
    s_cbranch_scc1 L_A_pv
    ds_read_b128 v[176:179], v232 offset:0
    ds_read_b128 v[180:183], v233 offset:0
    ds_read_b128 v[184:187], v234 offset:0
    ds_read_b128 v[188:191], v235 offset:0
    s_waitcnt lgkmcnt(3)
    v_mfma_f32_32x32x16_bf16 v[160:175], v[32:35], v[176:179], 0
    ds_read_b128 v[176:179], v236 offset:0
    s_waitcnt lgkmcnt(3)
    v_mfma_f32_32x32x16_bf16 v[160:175], v[36:39], v[180:183], v[160:175]
    ds_read_b128 v[180:183], v237 offset:0
    s_waitcnt lgkmcnt(3)
    v_mfma_f32_32x32x16_bf16 v[160:175], v[40:43], v[184:187], v[160:175]
    ds_read_b128 v[184:187], v238 offset:0
    s_waitcnt lgkmcnt(3)
    v_mfma_f32_32x32x16_bf16 v[160:175], v[44:47], v[188:191], v[160:175]
    ds_read_b128 v[188:191], v239 offset:0
    s_waitcnt lgkmcnt(3)
    v_mfma_f32_32x32x16_bf16 v[160:175], v[48:51], v[176:179], v[160:175]
    ds_read_b128 v[176:179], v232 offset:256
    s_waitcnt lgkmcnt(3)
    v_mfma_f32_32x32x16_bf16 v[160:175], v[52:55], v[180:183], v[160:175]
    ds_read_b128 v[180:183], v233 offset:256
    s_waitcnt lgkmcnt(3)
    v_mfma_f32_32x32x16_bf16 v[160:175], v[56:59], v[184:187], v[160:175]
    ds_read_b128 v[184:187], v234 offset:256
    s_waitcnt lgkmcnt(3)
    v_mfma_f32_32x32x16_bf16 v[160:175], v[60:63], v[188:191], v[160:175]
    ds_read_b128 v[188:191], v235 offset:256
    s_waitcnt lgkmcnt(3)
    v_mfma_f32_32x32x16_bf16 v[160:175], v[64:67], v[176:179], v[160:175]
    ds_read_b128 v[176:179], v236 offset:256
    s_waitcnt lgkmcnt(3)
    v_mfma_f32_32x32x16_bf16 v[160:175], v[68:71], v[180:183], v[160:175]
    ds_read_b128 v[180:183], v237 offset:256
    s_waitcnt lgkmcnt(3)
    v_mfma_f32_32x32x16_bf16 v[160:175], v[72:75], v[184:187], v[160:175]
    ds_read_b128 v[184:187], v238 offset:256
    s_waitcnt lgkmcnt(3)
    v_mfma_f32_32x32x16_bf16 v[160:175], v[76:79], v[188:191], v[160:175]
    ds_read_b128 v[188:191], v239 offset:256
    s_waitcnt lgkmcnt(3)
    v_mfma_f32_32x32x16_bf16 v[160:175], v[80:83], v[176:179], v[160:175]
    ds_read_b128 v[176:179], v232 offset:512
    s_waitcnt lgkmcnt(3)
    v_mfma_f32_32x32x16_bf16 v[160:175], v[84:87], v[180:183], v[160:175]
    ds_read_b128 v[180:183], v233 offset:512
    s_waitcnt lgkmcnt(3)
    v_mfma_f32_32x32x16_bf16 v[160:175], v[88:91], v[184:187], v[160:175]
    ds_read_b128 v[184:187], v234 offset:512
    s_waitcnt lgkmcnt(3)
    v_mfma_f32_32x32x16_bf16 v[160:175], v[92:95], v[188:191], v[160:175]
    ds_read_b128 v[188:191], v235 offset:512
    s_waitcnt lgkmcnt(3)
    v_mfma_f32_32x32x16_bf16 v[160:175], v[96:99], v[176:179], v[160:175]
    ds_read_b128 v[176:179], v236 offset:512
    s_waitcnt lgkmcnt(3)
    v_mfma_f32_32x32x16_bf16 v[160:175], v[100:103], v[180:183], v[160:175]
    ds_read_b128 v[180:183], v237 offset:512
    s_waitcnt lgkmcnt(3)
    v_mfma_f32_32x32x16_bf16 v[160:175], v[104:107], v[184:187], v[160:175]
    ds_read_b128 v[184:187], v238 offset:512
    s_waitcnt lgkmcnt(3)
    v_mfma_f32_32x32x16_bf16 v[160:175], v[108:111], v[188:191], v[160:175]
    ds_read_b128 v[188:191], v239 offset:512
    s_waitcnt lgkmcnt(3)
    v_mfma_f32_32x32x16_bf16 v[160:175], v[112:115], v[176:179], v[160:175]
    ds_read_b128 v[176:179], v232 offset:768
    s_waitcnt lgkmcnt(3)
    v_mfma_f32_32x32x16_bf16 v[160:175], v[116:119], v[180:183], v[160:175]
    ds_read_b128 v[180:183], v233 offset:768
    s_waitcnt lgkmcnt(3)
    v_mfma_f32_32x32x16_bf16 v[160:175], v[120:123], v[184:187], v[160:175]
    ds_read_b128 v[184:187], v234 offset:768
    s_waitcnt lgkmcnt(3)
    v_mfma_f32_32x32x16_bf16 v[160:175], v[124:127], v[188:191], v[160:175]
    ds_read_b128 v[188:191], v235 offset:768
    s_waitcnt lgkmcnt(3)
    v_mfma_f32_32x32x16_bf16 v[160:175], v[128:131], v[176:179], v[160:175]
    ds_read_b128 v[176:179], v236 offset:768
    s_waitcnt lgkmcnt(3)
    v_mfma_f32_32x32x16_bf16 v[160:175], v[132:135], v[180:183], v[160:175]
    ds_read_b128 v[180:183], v237 offset:768
    s_waitcnt lgkmcnt(3)
    v_mfma_f32_32x32x16_bf16 v[160:175], v[136:139], v[184:187], v[160:175]
    ds_read_b128 v[184:187], v238 offset:768
    s_waitcnt lgkmcnt(3)
    v_mfma_f32_32x32x16_bf16 v[160:175], v[140:143], v[188:191], v[160:175]
    ds_read_b128 v[188:191], v239 offset:768
    s_waitcnt lgkmcnt(3)
    v_mfma_f32_32x32x16_bf16 v[160:175], v[144:147], v[176:179], v[160:175]
    s_waitcnt lgkmcnt(2)
    v_mfma_f32_32x32x16_bf16 v[160:175], v[148:151], v[180:183], v[160:175]
    s_waitcnt lgkmcnt(1)
    v_mfma_f32_32x32x16_bf16 v[160:175], v[152:155], v[184:187], v[160:175]
    s_waitcnt lgkmcnt(0)
    v_mfma_f32_32x32x16_bf16 v[160:175], v[156:159], v[188:191], v[160:175]
    s_lshl_b32 s12, s3, 2
    v_lshlrev_b32 v29, 4, v24
    v_add_u32 v30, s12, v29
    v_mul_u32_u24 v31, 272, v24
    v_lshl_add_u32 v31, v25, 3, v31
    s_lshl_b32 s12, s3, 6
    v_add_u32 v31, s12, v31
    s_lshl_b32 s12, s2, 3
    s_add_u32 s12, s12, 704512
    v_lshlrev_b32 v22, 10, v24
    s_nop 1
    v_max3_f32 v27, v160, v161, v162
    v_max3_f32 v27, v27, v163, v164
    v_max3_f32 v27, v27, v165, v166
    v_max3_f32 v27, v27, v167, v168
    v_max3_f32 v27, v27, v169, v170
    v_max3_f32 v27, v27, v171, v172
    v_max3_f32 v27, v27, v173, v174
    v_max_f32 v27, v27, v175
    v_mov_b32 v28, v27
    s_nop 1
    v_permlane32_swap_b32 v27, v28
    s_nop 1
    v_max_f32 v27, v27, v28
    ds_write_b32 v30, v27 offset:0
    s_waitcnt lgkmcnt(0)
    s_barrier
    ds_read_b128 v[32:35], v29 offset:0
    s_waitcnt lgkmcnt(0)
    v_max3_f32 v27, v32, v33, v34
    v_max_f32 v27, v27, v35
    v_sub_f32 v160, v160, v27
    v_sub_f32 v161, v161, v27
    v_sub_f32 v162, v162, v27
    v_sub_f32 v163, v163, v27
    v_exp_f32 v160, v160
    v_exp_f32 v161, v161
    v_exp_f32 v162, v162
    v_exp_f32 v163, v163
    s_nop 0
    v_cvt_pk_bf16_f32 v32, v160, v161
    v_cvt_pk_bf16_f32 v33, v162, v163
    ds_write_b64 v31, v[32:33] offset:4096
    v_sub_f32 v164, v164, v27
    v_sub_f32 v165, v165, v27
    v_sub_f32 v166, v166, v27
    v_sub_f32 v167, v167, v27
    v_exp_f32 v164, v164
    v_exp_f32 v165, v165
    v_exp_f32 v166, v166
    v_exp_f32 v167, v167
    s_nop 0
    v_cvt_pk_bf16_f32 v34, v164, v165
    v_cvt_pk_bf16_f32 v35, v166, v167
    ds_write_b64 v31, v[34:35] offset:4112
    v_sub_f32 v168, v168, v27
    v_sub_f32 v169, v169, v27
    v_sub_f32 v170, v170, v27
    v_sub_f32 v171, v171, v27
    v_exp_f32 v168, v168
    v_exp_f32 v169, v169
    v_exp_f32 v170, v170
    v_exp_f32 v171, v171
    s_nop 0
    v_cvt_pk_bf16_f32 v36, v168, v169
    v_cvt_pk_bf16_f32 v37, v170, v171
    ds_write_b64 v31, v[36:37] offset:4128
    v_sub_f32 v172, v172, v27
    v_sub_f32 v173, v173, v27
    v_sub_f32 v174, v174, v27
    v_sub_f32 v175, v175, v27
    v_exp_f32 v172, v172
    v_exp_f32 v173, v173
    v_exp_f32 v174, v174
    v_exp_f32 v175, v175
    s_nop 0
    v_cvt_pk_bf16_f32 v38, v172, v173
    v_cvt_pk_bf16_f32 v39, v174, v175
    ds_write_b64 v31, v[38:39] offset:4144
    s_waitcnt lgkmcnt(0)
    s_barrier
    v_add_f32 v28, v160, v161
    v_add_f32 v28, v28, v162
    v_add_f32 v28, v28, v163
    v_add_f32 v28, v28, v164
    v_add_f32 v28, v28, v165
    v_add_f32 v28, v28, v166
    v_add_f32 v28, v28, v167
    v_add_f32 v28, v28, v168
    v_add_f32 v28, v28, v169
    v_add_f32 v28, v28, v170
    v_add_f32 v28, v28, v171
    v_add_f32 v28, v28, v172
    v_add_f32 v28, v28, v173
    v_add_f32 v28, v28, v174
    v_add_f32 v28, v28, v175
    v_mov_b32 v40, v28
    s_nop 1
    v_permlane32_swap_b32 v28, v40
    s_nop 1
    v_add_f32 v28, v28, v40
    ds_write_b32 v30, v28 offset:512
    s_lshl_b32 s12, s3, 8
    s_lshl_b32 s13, s2, 10
    s_add_u32 s12, s12, s13
    s_add_u32 s12, s12, 704512
    v_lshlrev_b32 v22, 3, v24
    s_waitcnt lgkmcnt(0)
    s_barrier
    ds_read_b128 v[36:39], v29 offset:512
    v_mov_b32 v32, v27
    s_waitcnt lgkmcnt(0)
    v_add_f32 v36, v36, v37
    v_add_f32 v38, v38, v39
    v_add_f32 v33, v36, v38
    s_mov_b32 exec_hi, 0
    buffer_store_dwordx2 v[32:33], v22, s[48:51], s12 offen sc1
    s_mov_b64 exec, -1
    s_mul_i32 s84, s74, 33024
    s_lshl_b32 s14, s3, 12
    s_add_u32 s84, s84, s14
    s_add_u32 s84, s84, 1048576
    v_lshrrev_b32 v29, 3, v2
    v_mul_u32_u24 v29, 576, v29
    v_lshl_add_u32 v29, v3, 4, v29
    s_lshl_b32 s14, s3, 6
    v_add_u32 v29, s14, v29
    v_lshlrev_b32 v30, 4, v0
    v_add_u32 v30, 65536, v30
    v_lshrrev_b32 v27, 3, v2
    v_lshlrev_b32 v27, 12, v27
    v_and_b32 v28, 3, v2
    v_lshl_add_u32 v27, v28, 10, v27
    v_bfe_u32 v28, v2, 2, 1
    v_lshl_add_u32 v27, v28, 9, v27
    v_and_b32 v28, 1, v3
    v_lshl_add_u32 v27, v28, 8, v27
    v_lshrrev_b32 v28, 1, v3
    v_lshl_add_u32 v27, v28, 4, v27
    s_add_u32 s14, s14, 65536
    v_add_u32 v27, s14, v27
    s_lshl_b32 s14, s3, 13
    s_add_u32 s14, s14, 98304
    v_add_u32 v20, s14, v26
    s_cmp_ge_u32 s3, 2
    s_cbranch_scc1 L_S5_w23
    s_lshl_b32 s12, s3, 16
    s_lshl_b32 s14, s73, 8
    s_add_u32 s12, s12, s14
    s_lshl_b32 s14, s72, 3
    s_add_u32 s12, s12, s14
    s_add_u32 s12, s12, 704512
    v_lshlrev_b32 v37, 10, v1
    v_and_b32 v38, 3, v1
    v_lshlrev_b32 v38, 2, v38
    v_bfe_u32 v28, v1, 2, 2
    v_and_b32 v36, 48, v1
    v_add3_u32 v38, v38, v28, v36
    v_lshlrev_b32 v38, 2, v38
    s_lshl_b32 s14, s3, 8
    v_add_u32 v38, s14, v38
    v_mov_b32 v21, 0
    s_mov_b32 s5, 0
L_sp1:
    ds_read_b32 v22, v21 offset:3584
    s_add_u32 s5, s5, 1
    s_waitcnt lgkmcnt(0)
    s_cmp_gt_u32 s5, 2000000
    s_cbranch_scc1 L_sp1_x
    v_cmp_ne_u32 vcc, s4, v22
    s_cbranch_vccnz L_sp1
L_sp1_x:
    s_mov_b32 s5, 0
    s_branch L_S5stat_l
L_S5stat:
L_S5stat_l:
    buffer_load_dwordx2 v[32:33], v37, s[48:51], s12 offen sc1
    s_waitcnt vmcnt(0)
L_S5stat_c:
    v_max_u32 v28, v32, v33
    s_add_u32 s5, s5, 1
    s_cmp_gt_u32 s5, 200000
    s_cbranch_scc1 L_S5stat_x
    v_cmp_eq_u32 vcc, -1, v28
    s_mov_b64 exec, vcc
    s_cbranch_execnz L_S5stat
L_S5stat_x:
    s_mov_b64 exec, -1
    buffer_load_dwordx4 v[96:99], v26, s[48:51], s84 offen offset:0 sc1
    buffer_load_dwordx4 v[100:103], v26, s[48:51], s84 offen offset:1024 sc1
    buffer_load_dwordx4 v[104:107], v26, s[48:51], s84 offen offset:2048 sc1
    buffer_load_dwordx4 v[108:111], v26, s[48:51], s84 offen offset:3072 sc1
    v_mov_b32 v34, v32
    s_nop 1
    v_max_f32_dpp v34, v34, v34 row_ror:8 row_mask:0xf bank_mask:0xf
    s_nop 1
    v_max_f32_dpp v34, v34, v34 row_ror:4 row_mask:0xf bank_mask:0xf
    s_nop 1
    v_max_f32_dpp v34, v34, v34 row_ror:2 row_mask:0xf bank_mask:0xf
    s_nop 1
    v_max_f32_dpp v34, v34, v34 row_ror:1 row_mask:0xf bank_mask:0xf
    v_mov_b32 v35, v34
    s_nop 1
    v_permlane16_swap_b32 v34, v35
    s_nop 1
    v_max_f32 v34, v34, v35
    v_mov_b32 v35, v34
    s_nop 1
    v_permlane32_swap_b32 v34, v35
    s_nop 1
    v_max_f32 v34, v34, v35
    v_sub_f32 v32, v32, v34
    v_exp_f32 v32, v32
    s_nop 0
    v_mul_f32 v33, v33, v32
    s_nop 1
    v_add_f32_dpp v33, v33, v33 row_ror:8 row_mask:0xf bank_mask:0xf
    s_nop 1
    v_add_f32_dpp v33, v33, v33 row_ror:4 row_mask:0xf bank_mask:0xf
    s_nop 1
    v_add_f32_dpp v33, v33, v33 row_ror:2 row_mask:0xf bank_mask:0xf
    s_nop 1
    v_add_f32_dpp v33, v33, v33 row_ror:1 row_mask:0xf bank_mask:0xf
    v_mov_b32 v35, v33
    s_nop 1
    v_permlane16_swap_b32 v33, v35
    s_nop 1
    v_add_f32 v33, v33, v35
    v_mov_b32 v35, v33
    s_nop 1
    v_permlane32_swap_b32 v33, v35
    s_nop 1
    v_add_f32 v33, v33, v35
    v_rcp_f32 v33, v33
    v_mul_f32 v32, 0x3f805bc0, v32
    v_mul_f32 v32, v32, v33
    v_cvt_pk_bf16_f32 v33, v32, v32
    v_and_b32 v34, 0xffff0000, v33
    v_sub_f32 v34, v32, v34
    v_cvt_pk_bf16_f32 v34, v34, v34
    ds_write_b32 v38, v33 offset:2048
    ds_write_b32 v38, v34 offset:2624
    s_waitcnt lgkmcnt(0)
    s_branch L_S5_chk
L_S5_w23:
    v_mov_b32 v21, 0
    s_mov_b32 s5, 0
L_sp2:
    ds_read_b32 v22, v21 offset:3588
    s_add_u32 s5, s5, 1
    s_waitcnt lgkmcnt(0)
    s_cmp_gt_u32 s5, 2000000
    s_cbranch_scc1 L_sp2_x
    v_cmp_ne_u32 vcc, s4, v22
    s_cbranch_vccnz L_sp2
L_sp2_x:
    s_branch L_S5_ld
L_A_pv:
    v_mul_u32_u24 v31, 272, v24
    v_lshl_add_u32 v31, v25, 4, v31
    v_mul_u32_u24 v27, 144, v24
    v_lshl_add_u32 v27, v25, 3, v27
    s_mul_i32 s13, s3, 4608
    s_add_u32 s13, s13, 16384
    v_add_u32 v27, s13, v27
    v_lshrrev_b32 v28, 3, v1
    v_mul_u32_u24 v28, 144, v28
    v_and_b32 v29, 7, v1
    v_lshl_add_u32 v28, v29, 4, v28
    v_add_u32 v28, s13, v28
    s_and_b32 s12, s3, 3
    s_lshl_b32 s8, s73, 7
    s_lshl_b32 s13, s12, 5
    s_add_u32 s8, s8, s13
    v_lshl_add_u32 v20, v3, 2, s8
    v_lshlrev_b32 v20, 13, v20
    v_lshl_add_u32 v20, v2, 4, v20
    s_lshl_b32 s75, s72, 8
    s_lshl_b32 s12, s12, 13
    s_add_u32 s12, s12, 98304
    s_add_u32 s13, s12, 0
    s_mov_b32 m0, s13
    s_add_u32 s13, s75, 0
    buffer_load_dwordx4 v20, s[56:59], s13 offen nt lds
    s_add_u32 s13, s12, 1024
    s_mov_b32 m0, s13
    s_add_u32 s13, s75, 8192
    buffer_load_dwordx4 v20, s[56:59], s13 offen nt lds
    s_add_u32 s13, s12, 2048
    s_mov_b32 m0, s13
    s_add_u32 s13, s75, 16384
    buffer_load_dwordx4 v20, s[56:59], s13 offen nt lds
    s_add_u32 s13, s12, 3072
    s_mov_b32 m0, s13
    s_add_u32 s13, s75, 24576
    buffer_load_dwordx4 v20, s[56:59], s13 offen nt lds
    s_add_u32 s13, s12, 4096
    s_mov_b32 m0, s13
    s_add_u32 s13, s75, 131072
    buffer_load_dwordx4 v20, s[56:59], s13 offen nt lds
    s_add_u32 s13, s12, 5120
    s_mov_b32 m0, s13
    s_add_u32 s13, s75, 139264
    buffer_load_dwordx4 v20, s[56:59], s13 offen nt lds
    s_add_u32 s13, s12, 6144
    s_mov_b32 m0, s13
    s_add_u32 s13, s75, 147456
    buffer_load_dwordx4 v20, s[56:59], s13 offen nt lds
    s_add_u32 s13, s12, 7168
    s_mov_b32 m0, s13
    s_add_u32 s13, s75, 155648
    buffer_load_dwordx4 v20, s[56:59], s13 offen nt lds
    s_mul_i32 s84, s74, 33024
    s_lshl_b32 s14, s3, 12
    s_add_u32 s84, s84, s14
    s_add_u32 s84, s84, 1048576
    v_lshrrev_b32 v29, 3, v2
    v_mul_u32_u24 v29, 576, v29
    v_lshl_add_u32 v29, v3, 4, v29
    s_lshl_b32 s14, s3, 6
    v_add_u32 v29, s14, v29
    v_lshlrev_b32 v30, 4, v0
    v_add_u32 v30, 65536, v30
    v_mov_b32 v21, 0
    v_mov_b32 v22, s4
    s_barrier
    s_barrier
    ds_read_b128 v[192:195], v31 offset:4096
    ds_read_b128 v[196:199], v31 offset:4128
    ds_read_b128 v[200:203], v31 offset:4160
    ds_read_b128 v[204:207], v31 offset:4192
    ds_read_b128 v[208:211], v31 offset:4224
    ds_read_b128 v[212:215], v31 offset:4256
    ds_read_b128 v[216:219], v31 offset:4288
    ds_read_b128 v[220:223], v31 offset:4320
    s_waitcnt lgkmcnt(7)
    v_mfma_f32_32x32x16_bf16 v[160:175], v[32:35], v[192:195], 0
    v_mfma_f32_32x32x16_bf16 v[176:191], v[64:67], v[192:195], 0
    s_waitcnt lgkmcnt(6)
    v_mfma_f32_32x32x16_bf16 v[160:175], v[36:39], v[196:199], v[160:175]
    v_mfma_f32_32x32x16_bf16 v[176:191], v[68:71], v[196:199], v[176:191]
    s_waitcnt lgkmcnt(5)
    v_mfma_f32_32x32x16_bf16 v[160:175], v[40:43], v[200:203], v[160:175]
    v_mfma_f32_32x32x16_bf16 v[176:191], v[72:75], v[200:203], v[176:191]
    s_barrier
    s_waitcnt lgkmcnt(4)
    v_mfma_f32_32x32x16_bf16 v[160:175], v[44:47], v[204:207], v[160:175]
    v_mfma_f32_32x32x16_bf16 v[176:191], v[76:79], v[204:207], v[176:191]
    s_waitcnt lgkmcnt(3)
    v_mfma_f32_32x32x16_bf16 v[160:175], v[48:51], v[208:211], v[160:175]
    v_mfma_f32_32x32x16_bf16 v[176:191], v[80:83], v[208:211], v[176:191]
    s_waitcnt lgkmcnt(2)
    v_mfma_f32_32x32x16_bf16 v[160:175], v[52:55], v[212:215], v[160:175]
    v_mfma_f32_32x32x16_bf16 v[176:191], v[84:87], v[212:215], v[176:191]
    s_waitcnt lgkmcnt(1)
    v_mfma_f32_32x32x16_bf16 v[160:175], v[56:59], v[216:219], v[160:175]
    v_mfma_f32_32x32x16_bf16 v[176:191], v[88:91], v[216:219], v[176:191]
    s_waitcnt lgkmcnt(0)
    v_mfma_f32_32x32x16_bf16 v[160:175], v[60:63], v[220:223], v[160:175]
    v_mfma_f32_32x32x16_bf16 v[176:191], v[92:95], v[220:223], v[176:191]
    v_mfma_f32_32x32x16_bf16 v[32:47], v[96:99], v[192:195], 0
    v_mfma_f32_32x32x16_bf16 v[48:63], v[128:131], v[192:195], 0
    v_mfma_f32_32x32x16_bf16 v[32:47], v[100:103], v[196:199], v[32:47]
    v_mfma_f32_32x32x16_bf16 v[48:63], v[132:135], v[196:199], v[48:63]
    v_cvt_pk_bf16_f32 v224, v160, v161
    v_cvt_pk_bf16_f32 v225, v162, v163
    ds_write_b64 v27, v[224:225] offset:0
    v_cvt_pk_bf16_f32 v226, v164, v165
    v_cvt_pk_bf16_f32 v227, v166, v167
    ds_write_b64 v27, v[226:227] offset:16
    v_mfma_f32_32x32x16_bf16 v[32:47], v[104:107], v[200:203], v[32:47]
    v_mfma_f32_32x32x16_bf16 v[48:63], v[136:139], v[200:203], v[48:63]
    v_cvt_pk_bf16_f32 v228, v168, v169
    v_cvt_pk_bf16_f32 v229, v170, v171
    ds_write_b64 v27, v[228:229] offset:32
    v_cvt_pk_bf16_f32 v230, v172, v173
    v_cvt_pk_bf16_f32 v231, v174, v175
    ds_write_b64 v27, v[230:231] offset:48
    v_mfma_f32_32x32x16_bf16 v[32:47], v[108:111], v[204:207], v[32:47]
    v_mfma_f32_32x32x16_bf16 v[48:63], v[140:143], v[204:207], v[48:63]
    v_cvt_pk_bf16_f32 v224, v176, v177
    v_cvt_pk_bf16_f32 v225, v178, v179
    ds_write_b64 v27, v[224:225] offset:64
    v_cvt_pk_bf16_f32 v226, v180, v181
    v_cvt_pk_bf16_f32 v227, v182, v183
    ds_write_b64 v27, v[226:227] offset:80
    v_mfma_f32_32x32x16_bf16 v[32:47], v[112:115], v[208:211], v[32:47]
    v_mfma_f32_32x32x16_bf16 v[48:63], v[144:147], v[208:211], v[48:63]
    v_cvt_pk_bf16_f32 v228, v184, v185
    v_cvt_pk_bf16_f32 v229, v186, v187
    ds_write_b64 v27, v[228:229] offset:96
    v_cvt_pk_bf16_f32 v230, v188, v189
    v_cvt_pk_bf16_f32 v231, v190, v191
    ds_write_b64 v27, v[230:231] offset:112
    v_mfma_f32_32x32x16_bf16 v[32:47], v[116:119], v[212:215], v[32:47]
    v_mfma_f32_32x32x16_bf16 v[48:63], v[148:151], v[212:215], v[48:63]
    s_waitcnt lgkmcnt(0)
    ds_read_b128 v[232:235], v28 offset:0
    ds_read_b128 v[236:239], v28 offset:1152
    ds_read_b128 v[240:243], v28 offset:2304
    ds_read_b128 v[244:247], v28 offset:3456
    v_mfma_f32_32x32x16_bf16 v[32:47], v[120:123], v[216:219], v[32:47]
    v_mfma_f32_32x32x16_bf16 v[48:63], v[152:155], v[216:219], v[48:63]
    v_mfma_f32_32x32x16_bf16 v[32:47], v[124:127], v[220:223], v[32:47]
    v_mfma_f32_32x32x16_bf16 v[48:63], v[156:159], v[220:223], v[48:63]
    s_waitcnt lgkmcnt(3)
    v_bfi_b32 v232, s79, v248, v232
    v_bfi_b32 v233, s79, v249, v233
    v_bfi_b32 v234, s79, v250, v234
    v_bfi_b32 v235, s79, v251, v235
    buffer_store_dwordx4 v[232:235], v23, s[48:51], s68 offen sc1
    s_waitcnt lgkmcnt(2)
    v_bfi_b32 v236, s79, v248, v236
    v_bfi_b32 v237, s79, v249, v237
    v_bfi_b32 v238, s79, v250, v238
    v_bfi_b32 v239, s79, v251, v239
    buffer_store_dwordx4 v[236:239], v23, s[48:51], s69 offen sc1
    s_waitcnt lgkmcnt(1)
    v_bfi_b32 v240, s79, v248, v240
    v_bfi_b32 v241, s79, v249, v241
    v_bfi_b32 v242, s79, v250, v242
    v_bfi_b32 v243, s79, v251, v243
    buffer_store_dwordx4 v[240:243], v23, s[48:51], s70 offen sc1
    s_waitcnt lgkmcnt(0)
    v_bfi_b32 v244, s79, v248, v244
    v_bfi_b32 v245, s79, v249, v245
    v_bfi_b32 v246, s79, v250, v246
    v_bfi_b32 v247, s79, v251, v247
    buffer_store_dwordx4 v[244:247], v23, s[48:51], s71 offen sc1
    s_nop 3
    v_cvt_pk_bf16_f32 v224, v32, v33
    v_cvt_pk_bf16_f32 v225, v34, v35
    ds_write_b64 v27, v[224:225] offset:0
    v_cvt_pk_bf16_f32 v226, v36, v37
    v_cvt_pk_bf16_f32 v227, v38, v39
    ds_write_b64 v27, v[226:227] offset:16
    v_cvt_pk_bf16_f32 v228, v40, v41
    v_cvt_pk_bf16_f32 v229, v42, v43
    ds_write_b64 v27, v[228:229] offset:32
    v_cvt_pk_bf16_f32 v230, v44, v45
    v_cvt_pk_bf16_f32 v231, v46, v47
    ds_write_b64 v27, v[230:231] offset:48
    v_cvt_pk_bf16_f32 v224, v48, v49
    v_cvt_pk_bf16_f32 v225, v50, v51
    ds_write_b64 v27, v[224:225] offset:64
    v_cvt_pk_bf16_f32 v226, v52, v53
    v_cvt_pk_bf16_f32 v227, v54, v55
    ds_write_b64 v27, v[226:227] offset:80
    v_cvt_pk_bf16_f32 v228, v56, v57
    v_cvt_pk_bf16_f32 v229, v58, v59
    ds_write_b64 v27, v[228:229] offset:96
    v_cvt_pk_bf16_f32 v230, v60, v61
    v_cvt_pk_bf16_f32 v231, v62, v63
    ds_write_b64 v27, v[230:231] offset:112
    s_waitcnt lgkmcnt(0)
    ds_read_b128 v[64:67], v28 offset:0
    ds_read_b128 v[68:71], v28 offset:1152
    ds_read_b128 v[72:75], v28 offset:2304
    ds_read_b128 v[76:79], v28 offset:3456
    s_waitcnt lgkmcnt(3)
    v_bfi_b32 v64, s79, v248, v64
    v_bfi_b32 v65, s79, v249, v65
    v_bfi_b32 v66, s79, v250, v66
    v_bfi_b32 v67, s79, v251, v67
    buffer_store_dwordx4 v[64:67], v23, s[48:51], s68 offen offset:128 sc1
    s_waitcnt lgkmcnt(2)
    v_bfi_b32 v68, s79, v248, v68
    v_bfi_b32 v69, s79, v249, v69
    v_bfi_b32 v70, s79, v250, v70
    v_bfi_b32 v71, s79, v251, v71
    buffer_store_dwordx4 v[68:71], v23, s[48:51], s69 offen offset:128 sc1
    s_waitcnt lgkmcnt(1)
    v_bfi_b32 v72, s79, v248, v72
    v_bfi_b32 v73, s79, v249, v73
    v_bfi_b32 v74, s79, v250, v74
    v_bfi_b32 v75, s79, v251, v75
    buffer_store_dwordx4 v[72:75], v23, s[48:51], s70 offen offset:128 sc1
    s_waitcnt lgkmcnt(0)
    v_bfi_b32 v76, s79, v248, v76
    v_bfi_b32 v77, s79, v249, v77
    v_bfi_b32 v78, s79, v250, v78
    v_bfi_b32 v79, s79, v251, v79
    buffer_store_dwordx4 v[76:79], v23, s[48:51], s71 offen offset:128 sc1
    s_cmp_lg_u32 s3, 7
    s_cbranch_scc1 L_nf1
    ds_write_b32 v21, v22 offset:3584
L_nf1:
    s_waitcnt vmcnt(0)
    s_cmp_lg_u32 s3, 7
    s_cbranch_scc1 L_S5_ld
    ds_write_b32 v21, v22 offset:3588
L_S5_ld:
    buffer_load_dwordx4 v[96:99], v26, s[48:51], s84 offen offset:0 sc1
    buffer_load_dwordx4 v[100:103], v26, s[48:51], s84 offen offset:1024 sc1
    buffer_load_dwordx4 v[104:107], v26, s[48:51], s84 offen offset:2048 sc1
    buffer_load_dwordx4 v[108:111], v26, s[48:51], s84 offen offset:3072 sc1
L_S5_chk:
    s_mov_b32 s5, 0
L_S5chk:
    s_waitcnt vmcnt(0)
    s_mov_b32 s7, 0
    v_xor_b32 v112, v96, v248
    v_xor_b32 v113, v97, v249
    v_xor_b32 v114, v98, v250
    v_xor_b32 v115, v99, v251
    v_or3_b32 v28, v112, v113, v114
    v_or_b32 v28, v28, v115
    v_and_b32 v28, s79, v28
    v_cmp_ne_u32 vcc, 0, v28
    s_cbranch_vccz L_S5chk_ok0
    buffer_load_dwordx4 v[96:99], v26, s[48:51], s84 offen offset:0 sc1
    s_mov_b32 s7, 1
L_S5chk_ok0:
    v_xor_b32 v116, v100, v248
    v_xor_b32 v117, v101, v249
    v_xor_b32 v118, v102, v250
    v_xor_b32 v119, v103, v251
    v_or3_b32 v28, v116, v117, v118
    v_or_b32 v28, v28, v119
    v_and_b32 v28, s79, v28
    v_cmp_ne_u32 vcc, 0, v28
    s_cbranch_vccz L_S5chk_ok1
    buffer_load_dwordx4 v[100:103], v26, s[48:51], s84 offen offset:1024 sc1
    s_mov_b32 s7, 1
L_S5chk_ok1:
    v_xor_b32 v120, v104, v248
    v_xor_b32 v121, v105, v249
    v_xor_b32 v122, v106, v250
    v_xor_b32 v123, v107, v251
    v_or3_b32 v28, v120, v121, v122
    v_or_b32 v28, v28, v123
    v_and_b32 v28, s79, v28
    v_cmp_ne_u32 vcc, 0, v28
    s_cbranch_vccz L_S5chk_ok2
    buffer_load_dwordx4 v[104:107], v26, s[48:51], s84 offen offset:2048 sc1
    s_mov_b32 s7, 1
L_S5chk_ok2:
    v_xor_b32 v124, v108, v248
    v_xor_b32 v125, v109, v249
    v_xor_b32 v126, v110, v250
    v_xor_b32 v127, v111, v251
    v_or3_b32 v28, v124, v125, v126
    v_or_b32 v28, v28, v127
    v_and_b32 v28, s79, v28
    v_cmp_ne_u32 vcc, 0, v28
    s_cbranch_vccz L_S5chk_ok3
    buffer_load_dwordx4 v[108:111], v26, s[48:51], s84 offen offset:3072 sc1
    s_mov_b32 s7, 1
L_S5chk_ok3:
    s_add_u32 s5, s5, 1
    s_cmp_gt_u32 s5, 200000
    s_cbranch_scc1 L_S5chk_d
    s_cmp_eq_u32 s7, 1
    s_cbranch_scc1 L_S5chk
L_S5chk_d:
    s_barrier
    ds_read_b128 v[16:19], v29 offset:2048
    s_cmp_ge_u32 s3, 4
    s_cbranch_scc1 L_S5_nw
    ds_read_b128 v[192:195], v20 offset:0
    ds_read_b128 v[196:199], v20 offset:1024
    ds_read_b128 v[200:203], v20 offset:2048
    ds_read_b128 v[204:207], v20 offset:3072
    ds_read_b128 v[208:211], v20 offset:4096
    ds_read_b128 v[212:215], v20 offset:5120
    ds_read_b128 v[216:219], v20 offset:6144
    ds_read_b128 v[220:223], v20 offset:7168
    s_waitcnt lgkmcnt(8)
    s_branch L_S5_mm
L_S5_nw:
    s_waitcnt lgkmcnt(0)
L_S5_mm:
    v_and_b32 v8, v16, v4
    v_and_b32 v9, v16, v5
    v_and_b32 v10, v16, v6
    v_and_b32 v11, v16, v7
    v_and_b32 v12, v17, v4
    v_and_b32 v13, v17, v5
    v_and_b32 v14, v17, v6
    v_and_b32 v15, v17, v7
    v_mfma_f32_16x16x32_bf16 v[32:35], v[8:11], v[112:115], 0
    v_and_b32 v8, v18, v4
    v_and_b32 v9, v18, v5
    v_and_b32 v10, v18, v6
    v_and_b32 v11, v18, v7
    v_mfma_f32_16x16x32_bf16 v[32:35], v[12:15], v[116:119], v[32:35]
    v_and_b32 v12, v19, v4
    v_and_b32 v13, v19, v5
    v_and_b32 v14, v19, v6
    v_and_b32 v15, v19, v7
    v_mfma_f32_16x16x32_bf16 v[32:35], v[8:11], v[120:123], v[32:35]
    s_nop 1
    v_mfma_f32_16x16x32_bf16 v[32:35], v[12:15], v[124:127], v[32:35]
    s_nop 7
    ds_write_b128 v30, v[32:35]
    s_waitcnt lgkmcnt(0)
    s_barrier
    s_cmp_ge_u32 s3, 4
    s_cbranch_scc1 L_S5_b6
    ds_read_b128 v[40:43], v27
    ds_read_b128 v[44:47], v27 offset:32
    s_waitcnt lgkmcnt(0)
    v_add_f32_dpp v40, v40, v40 quad_perm:[1,0,3,2] row_mask:0xf bank_mask:0xf
    v_add_f32_dpp v41, v41, v41 quad_perm:[1,0,3,2] row_mask:0xf bank_mask:0xf
    v_add_f32_dpp v42, v42, v42 quad_perm:[1,0,3,2] row_mask:0xf bank_mask:0xf
    v_add_f32_dpp v43, v43, v43 quad_perm:[1,0,3,2] row_mask:0xf bank_mask:0xf
    v_add_f32_dpp v44, v44, v44 quad_perm:[1,0,3,2] row_mask:0xf bank_mask:0xf
    v_add_f32_dpp v45, v45, v45 quad_perm:[1,0,3,2] row_mask:0xf bank_mask:0xf
    v_add_f32_dpp v46, v46, v46 quad_perm:[1,0,3,2] row_mask:0xf bank_mask:0xf
    v_add_f32_dpp v47, v47, v47 quad_perm:[1,0,3,2] row_mask:0xf bank_mask:0xf
    v_add_f32_dpp v40, v40, v40 quad_perm:[2,3,0,1] row_mask:0xf bank_mask:0xf
    v_add_f32_dpp v41, v41, v41 quad_perm:[2,3,0,1] row_mask:0xf bank_mask:0xf
    v_add_f32_dpp v42, v42, v42 quad_perm:[2,3,0,1] row_mask:0xf bank_mask:0xf
    v_add_f32_dpp v43, v43, v43 quad_perm:[2,3,0,1] row_mask:0xf bank_mask:0xf
    v_add_f32_dpp v44, v44, v44 quad_perm:[2,3,0,1] row_mask:0xf bank_mask:0xf
    v_add_f32_dpp v45, v45, v45 quad_perm:[2,3,0,1] row_mask:0xf bank_mask:0xf
    v_add_f32_dpp v46, v46, v46 quad_perm:[2,3,0,1] row_mask:0xf bank_mask:0xf
    v_add_f32_dpp v47, v47, v47 quad_perm:[2,3,0,1] row_mask:0xf bank_mask:0xf
    v_add_f32_dpp v40, v40, v40 row_half_mirror row_mask:0xf bank_mask:0xf
    v_add_f32_dpp v41, v41, v41 row_half_mirror row_mask:0xf bank_mask:0xf
    v_add_f32_dpp v42, v42, v42 row_half_mirror row_mask:0xf bank_mask:0xf
    v_add_f32_dpp v43, v43, v43 row_half_mirror row_mask:0xf bank_mask:0xf
    v_add_f32_dpp v44, v44, v44 row_half_mirror row_mask:0xf bank_mask:0xf
    v_add_f32_dpp v45, v45, v45 row_half_mirror row_mask:0xf bank_mask:0xf
    v_add_f32_dpp v46, v46, v46 row_half_mirror row_mask:0xf bank_mask:0xf
    v_add_f32_dpp v47, v47, v47 row_half_mirror row_mask:0xf bank_mask:0xf
    v_cvt_pk_bf16_f32 v40, v40, v40
    v_cvt_pk_bf16_f32 v41, v41, v41
    v_cvt_pk_bf16_f32 v42, v42, v42
    v_cvt_pk_bf16_f32 v43, v43, v43
    v_cvt_pk_bf16_f32 v44, v44, v44
    v_cvt_pk_bf16_f32 v45, v45, v45
    v_cvt_pk_bf16_f32 v46, v46, v46
    v_cvt_pk_bf16_f32 v47, v47, v47
    v_and_b32 v8, v40, v4
    v_and_b32 v9, v40, v5
    v_and_b32 v10, v40, v6
    v_and_b32 v11, v40, v7
    v_and_b32 v12, v41, v4
    v_and_b32 v13, v41, v5
    v_and_b32 v14, v41, v6
    v_and_b32 v15, v41, v7
    v_mfma_f32_16x16x32_bf16 v[32:35], v[8:11], v[192:195], 0
    v_and_b32 v8, v42, v4
    v_and_b32 v9, v42, v5
    v_and_b32 v10, v42, v6
    v_and_b32 v11, v42, v7
    v_mfma_f32_16x16x32_bf16 v[32:35], v[12:15], v[196:199], v[32:35]
    v_and_b32 v12, v43, v4
    v_and_b32 v13, v43, v5
    v_and_b32 v14, v43, v6
    v_and_b32 v15, v43, v7
    v_mfma_f32_16x16x32_bf16 v[32:35], v[8:11], v[200:203], v[32:35]
    v_and_b32 v8, v44, v4
    v_and_b32 v9, v44, v5
    v_and_b32 v10, v44, v6
    v_and_b32 v11, v44, v7
    v_mfma_f32_16x16x32_bf16 v[32:35], v[12:15], v[204:207], v[32:35]
    v_and_b32 v12, v45, v4
    v_and_b32 v13, v45, v5
    v_and_b32 v14, v45, v6
    v_and_b32 v15, v45, v7
    v_mfma_f32_16x16x32_bf16 v[32:35], v[8:11], v[208:211], v[32:35]
    v_and_b32 v8, v46, v4
    v_and_b32 v9, v46, v5
    v_and_b32 v10, v46, v6
    v_and_b32 v11, v46, v7
    v_mfma_f32_16x16x32_bf16 v[32:35], v[12:15], v[212:215], v[32:35]
    v_and_b32 v12, v47, v4
    v_and_b32 v13, v47, v5
    v_and_b32 v14, v47, v6
    v_and_b32 v15, v47, v7
    v_mfma_f32_16x16x32_bf16 v[32:35], v[8:11], v[216:219], v[32:35]
    s_nop 1
    v_mfma_f32_16x16x32_bf16 v[32:35], v[12:15], v[220:223], v[32:35]
    s_nop 7
    ds_write_b128 v30, v[32:35] offset:16384
    s_waitcnt lgkmcnt(0)
L_S5_b6:
    s_barrier
    s_cmp_lg_u32 s3, 0
    s_cbranch_scc1 L_S9
    v_lshrrev_b32 v27, 1, v3
    v_mul_u32_u24 v27, 256, v27
    v_lshl_add_u32 v27, v2, 4, v27
    v_and_b32 v28, 1, v3
    v_lshl_add_u32 v27, v28, 3, v27
    s_lshl_b32 s12, s74, 9
    s_add_u32 s12, s12, 294912
    ds_read_b128 v[64:67], v30 offset:16384
    ds_read_b128 v[68:71], v30 offset:17408
    ds_read_b128 v[72:75], v30 offset:18432
    ds_read_b128 v[76:79], v30 offset:19456
    s_waitcnt lgkmcnt(2)
    v_pk_add_f32 v[64:65], v[64:65], v[68:69]
    v_pk_add_f32 v[66:67], v[66:67], v[70:71]
    s_waitcnt lgkmcnt(1)
    v_pk_add_f32 v[64:65], v[64:65], v[72:73]
    v_pk_add_f32 v[66:67], v[66:67], v[74:75]
    s_waitcnt lgkmcnt(0)
    v_pk_add_f32 v[32:33], v[64:65], v[76:77]
    v_pk_add_f32 v[34:35], v[66:67], v[78:79]
    v_cvt_pk_bf16_f32 v32, v32, v33
    v_cvt_pk_bf16_f32 v33, v34, v35
    buffer_store_dwordx2 v[32:33], v27, s[48:51], s12 offen sc1
L_S9:
    s_cmp_ge_u32 s2, 80
    s_cbranch_scc1 L_fin
    s_cmp_lg_u32 s3, 1
    s_cbranch_scc1 L_fin
    s_mov_b32 s60, s40
    s_mov_b32 s61, s41
    s_mov_b32 s62, 2560
    s_mov_b32 s63, 0x00020000
    s_mov_b32 s12, s2
    s_lshl_b32 s13, s12, 6
    s_add_u32 s13, s13, 425984
    s_add_u32 s14, s13, 81920
    s_add_u32 s15, s13, 163840
    v_lshrrev_b32 v27, 2, v1
    v_and_b32 v28, 3, v1
    v_mul_u32_u24 v29, 5120, v27
    v_lshl_add_u32 v29, v28, 4, v29
    v_add_u32 v30, 245760, v29
    v_cmp_gt_u32 vcc, 6, v27
    v_mov_b32 v31, 0x7fffff00
    s_nop 0
    v_cndmask_b32 v30, v31, v30, vcc
    s_mov_b64 exec, 1
    s_mov_b32 s5, 0
    s_branch L_S9gate_l
L_S9gate:
    s_sleep 2
L_S9gate_l:
    buffer_load_dword v32, v29, s[48:51], s13 offen sc1
    s_waitcnt vmcnt(0)
L_S9gate_c:
    s_add_u32 s5, s5, 1
    s_cmp_gt_u32 s5, 200000
    s_cbranch_scc1 L_S9gate_x
    v_cmp_eq_u32 vcc, -1, v32
    s_mov_b64 exec, vcc
    s_cbranch_execnz L_S9gate
L_S9gate_x:
    s_mov_b64 exec, -1
    s_mov_b32 s5, 0
    s_branch L_S9data_l
L_S9data:
L_S9data_l:
    buffer_load_dwordx4 v[32:35], v29, s[48:51], s13 offen sc1
    buffer_load_dwordx4 v[36:39], v29, s[48:51], s14 offen sc1
    buffer_load_dwordx4 v[40:43], v29, s[48:51], s15 offen sc1
    buffer_load_dwordx4 v[44:47], v30, s[48:51], s13 offen sc1
    s_waitcnt vmcnt(0)
L_S9data_c:
    v_max3_u32 v31, v32, v33, v34
    v_max3_u32 v31, v31, v35, v36
    v_max3_u32 v31, v31, v37, v38
    v_max3_u32 v31, v31, v39, v40
    v_max3_u32 v31, v31, v41, v42
    v_max3_u32 v31, v31, v43, v44
    v_max3_u32 v31, v31, v45, v46
    v_max_u32 v31, v31, v47
    s_add_u32 s5, s5, 1
    s_cmp_gt_u32 s5, 200000
    s_cbranch_scc1 L_S9data_x
    v_cmp_eq_u32 vcc, -1, v31
    s_mov_b64 exec, vcc
    s_cbranch_execnz L_S9data
L_S9data_x:
    s_mov_b64 exec, -1
    v_pk_add_f32 v[32:33], v[32:33], v[36:37]
    v_pk_add_f32 v[34:35], v[34:35], v[38:39]
    v_pk_add_f32 v[40:41], v[40:41], v[44:45]
    v_pk_add_f32 v[42:43], v[42:43], v[46:47]
    v_pk_add_f32 v[32:33], v[32:33], v[40:41]
    v_pk_add_f32 v[34:35], v[34:35], v[42:43]
    s_nop 1
    v_add_f32_dpp v32, v32, v32 row_ror:4 row_mask:0xf bank_mask:0xf
    v_add_f32_dpp v33, v33, v33 row_ror:4 row_mask:0xf bank_mask:0xf
    v_add_f32_dpp v34, v34, v34 row_ror:4 row_mask:0xf bank_mask:0xf
    v_add_f32_dpp v35, v35, v35 row_ror:4 row_mask:0xf bank_mask:0xf
    s_nop 1
    v_add_f32_dpp v32, v32, v32 row_ror:8 row_mask:0xf bank_mask:0xf
    v_add_f32_dpp v33, v33, v33 row_ror:8 row_mask:0xf bank_mask:0xf
    v_add_f32_dpp v34, v34, v34 row_ror:8 row_mask:0xf bank_mask:0xf
    v_add_f32_dpp v35, v35, v35 row_ror:8 row_mask:0xf bank_mask:0xf
    v_mov_b32 v36, v32
    v_mov_b32 v37, v33
    v_mov_b32 v38, v34
    v_mov_b32 v39, v35
    s_nop 0
    v_permlane16_swap_b32 v32, v36
    v_permlane16_swap_b32 v33, v37
    v_permlane16_swap_b32 v34, v38
    v_permlane16_swap_b32 v35, v39
    s_nop 0
    v_add_f32 v32, v32, v36
    v_add_f32 v33, v33, v37
    v_add_f32 v34, v34, v38
    v_add_f32 v35, v35, v39
    v_mov_b32 v36, v32
    v_mov_b32 v37, v33
    v_mov_b32 v38, v34
    v_mov_b32 v39, v35
    s_nop 0
    v_permlane32_swap_b32 v32, v36
    v_permlane32_swap_b32 v33, v37
    v_permlane32_swap_b32 v34, v38
    v_permlane32_swap_b32 v35, v39
    s_nop 0
    v_add_f32 v32, v32, v36
    v_add_f32 v33, v33, v37
    v_add_f32 v34, v34, v38
    v_add_f32 v35, v35, v39
    v_cvt_pk_bf16_f32 v32, v32, v33
    v_cvt_pk_bf16_f32 v33, v34, v35
    s_lshr_b32 s13, s12, 4
    s_lshl_b32 s13, s13, 8
    s_bfe_u32 s14, s12, 0x10003
    s_mul_i32 s14, s14, 1280
    s_add_u32 s13, s13, s14
    s_bfe_u32 s14, s12, 0x10002
    s_lshl_b32 s14, s14, 3
    s_add_u32 s13, s13, s14
    s_and_b32 s14, s12, 3
    s_lshl_b32 s14, s14, 6
    s_add_u32 s13, s13, s14
    v_lshlrev_b32 v28, 4, v28
    s_mov_b64 exec, 15
    buffer_store_dwordx2 v[32:33], v28, s[60:63], s13 offen
    s_cmp_lg_u32 s12, 0
    s_cbranch_scc1 L_noep
    s_mov_b64 exec, 1
    v_mov_b32 v34, s4
    v_mov_b32 v35, 2048
    buffer_store_dword v34, v35, s[48:51], 0 offen
L_noep:
    s_mov_b64 exec, -1
    s_branch L_fin
L_F:
    s_sub_u32 s10, s2, 128
L_F_s2:
    s_waitcnt lgkmcnt(0)
    s_mul_i32 s4, s46, 1664525
    s_add_u32 s4, s4, 1013904223
    s_mov_b32 s52, s20
    s_mov_b32 s53, s21
    s_mov_b32 s54, 5242880
    s_mov_b32 s55, 0x00020000
    s_mov_b32 s56, s22
    s_mov_b32 s57, s23
    s_mov_b32 s58, 4194304
    s_mov_b32 s59, 0x00020000
    s_and_b32 s11, s10, 7
    s_lshl_b32 s11, s11, 2
    s_bfe_u32 s12, s10, 0x20003
    s_xor_b32 s12, s12, 0
    s_add_u32 s11, s11, s12
    s_lshr_b32 s12, s10, 5
    s_lshl_b32 s14, s11, 8
    s_cmp_ge_u32 s3, 5
    s_cbranch_scc1 L_F_b0
    s_mul_i32 s13, s12, 160
    s_lshl_b32 s15, s3, 5
    s_add_u32 s13, s13, s15
    v_lshl_add_u32 v24, v3, 2, s13
    v_lshlrev_b32 v25, 13, v24
    v_lshl_add_u32 v25, v2, 4, v25
    s_add_u32 s15, s14, 0
    buffer_load_dwordx4 v[64:67], v25, s[52:55], s15 offen nt
    s_add_u32 s15, s14, 8192
    buffer_load_dwordx4 v[68:71], v25, s[52:55], s15 offen nt
    s_add_u32 s15, s14, 16384
    buffer_load_dwordx4 v[72:75], v25, s[52:55], s15 offen nt
    s_add_u32 s15, s14, 24576
    buffer_load_dwordx4 v[76:79], v25, s[52:55], s15 offen nt
    s_add_u32 s15, s14, 131072
    buffer_load_dwordx4 v[80:83], v25, s[52:55], s15 offen nt
    s_add_u32 s15, s14, 139264
    buffer_load_dwordx4 v[84:87], v25, s[52:55], s15 offen nt
    s_add_u32 s15, s14, 147456
    buffer_load_dwordx4 v[88:91], v25, s[52:55], s15 offen nt
    s_add_u32 s15, s14, 155648
    buffer_load_dwordx4 v[92:95], v25, s[52:55], s15 offen nt
    s_branch L_F_h1
L_F_b0:
    s_sub_u32 s15, s3, 5
    s_lshl_b32 s8, s15, 10
    s_add_u32 s8, s8, 32768
    s_lshl_b32 s9, s12, 20
    s_lshl_b32 s13, s15, 15
    s_add_u32 s9, s9, s13
    s_xor_b32 s13, s14, 512
    s_add_u32 s9, s9, s13
    v_xor_b32 v26, v3, v2
    v_lshlrev_b32 v26, 4, v26
    v_lshl_add_u32 v26, v3, 13, v26
    s_add_u32 s13, s15, 0
    s_and_b32 s13, s13, 3
    s_lshl_b32 s13, s13, 6
    v_xor_b32 v27, s13, v26
    s_add_u32 s13, s8, 0
    s_mov_b32 m0, s13
    s_add_u32 s13, s9, 0
    buffer_load_dwordx4 v27, s[56:59], s13 offen nt lds
    s_add_u32 s13, s15, 3
    s_and_b32 s13, s13, 3
    s_lshl_b32 s13, s13, 6
    v_xor_b32 v28, s13, v26
    s_add_u32 s13, s8, 3072
    s_mov_b32 m0, s13
    s_add_u32 s13, s9, 98304
    buffer_load_dwordx4 v28, s[56:59], s13 offen nt lds
    s_add_u32 s13, s15, 6
    s_and_b32 s13, s13, 3
    s_lshl_b32 s13, s13, 6
    v_xor_b32 v27, s13, v26
    s_add_u32 s13, s8, 6144
    s_mov_b32 m0, s13
    s_add_u32 s13, s9, 196608
    buffer_load_dwordx4 v27, s[56:59], s13 offen nt lds
    s_add_u32 s13, s15, 9
    s_and_b32 s13, s13, 3
    s_lshl_b32 s13, s13, 6
    v_xor_b32 v28, s13, v26
    s_add_u32 s13, s8, 9216
    s_mov_b32 m0, s13
    s_add_u32 s13, s9, 294912
    buffer_load_dwordx4 v28, s[56:59], s13 offen nt lds
    s_add_u32 s13, s15, 12
    s_and_b32 s13, s13, 3
    s_lshl_b32 s13, s13, 6
    v_xor_b32 v27, s13, v26
    s_add_u32 s13, s8, 12288
    s_mov_b32 m0, s13
    s_add_u32 s13, s9, 393216
    buffer_load_dwordx4 v27, s[56:59], s13 offen nt lds
    s_add_u32 s13, s15, 15
    s_and_b32 s13, s13, 3
    s_lshl_b32 s13, s13, 6
    v_xor_b32 v28, s13, v26
    s_add_u32 s13, s8, 15360
    s_mov_b32 m0, s13
    s_add_u32 s13, s9, 491520
    buffer_load_dwordx4 v28, s[56:59], s13 offen nt lds
    s_add_u32 s13, s15, 18
    s_and_b32 s13, s13, 3
    s_lshl_b32 s13, s13, 6
    v_xor_b32 v27, s13, v26
    s_add_u32 s13, s8, 18432
    s_mov_b32 m0, s13
    s_add_u32 s13, s9, 589824
    buffer_load_dwordx4 v27, s[56:59], s13 offen nt lds
    s_add_u32 s13, s15, 21
    s_and_b32 s13, s13, 3
    s_lshl_b32 s13, s13, 6
    v_xor_b32 v28, s13, v26
    s_add_u32 s13, s8, 21504
    s_mov_b32 m0, s13
    s_add_u32 s13, s9, 688128
    buffer_load_dwordx4 v28, s[56:59], s13 offen nt lds
    s_add_u32 s13, s15, 24
    s_and_b32 s13, s13, 3
    s_lshl_b32 s13, s13, 6
    v_xor_b32 v27, s13, v26
    s_add_u32 s13, s8, 24576
    s_mov_b32 m0, s13
    s_add_u32 s13, s9, 786432
    buffer_load_dwordx4 v27, s[56:59], s13 offen nt lds
    s_add_u32 s13, s15, 27
    s_and_b32 s13, s13, 3
    s_lshl_b32 s13, s13, 6
    v_xor_b32 v28, s13, v26
    s_add_u32 s13, s8, 27648
    s_mov_b32 m0, s13
    s_add_u32 s13, s9, 884736
    buffer_load_dwordx4 v28, s[56:59], s13 offen nt lds
    s_cmp_eq_u32 s3, 7
    s_cbranch_scc1 L_F_ukd
    s_add_u32 s13, s15, 30
    s_and_b32 s13, s13, 3
    s_lshl_b32 s13, s13, 6
    v_xor_b32 v27, s13, v26
    s_add_u32 s13, s8, 30720
    s_mov_b32 m0, s13
    s_add_u32 s13, s9, 983040
    buffer_load_dwordx4 v27, s[56:59], s13 offen nt lds
L_F_ukd:
    s_mul_i32 s15, s10, 6144
    s_add_u32 s15, s15, 294912
    s_min_u32 s15, s15, 993280
    v_subrev_u32 v26, 320, v0
    v_lshlrev_b32 v26, 4, v26
    v_mov_b32 v32, -1
    v_mov_b32 v33, -1
    v_mov_b32 v34, -1
    v_mov_b32 v35, -1
    buffer_store_dwordx4 v[32:35], v26, s[48:51], s15 offen sc1
    buffer_store_dwordx4 v[32:35], v26, s[48:51], s15 offen offset:3072 sc1
    s_waitcnt lgkmcnt(0)
    s_mul_i32 s4, s46, 1664525
    s_add_u32 s4, s4, 1013904223
    s_barrier
    s_waitcnt vmcnt(0)
    s_branch L_F_s3
L_F_h1:
    s_waitcnt lgkmcnt(0)
    s_mul_i32 s4, s46, 1664525
    s_add_u32 s4, s4, 1013904223
    s_cmp_lg_u32 s3, 0
    s_cbranch_scc1 L_nopw
    s_not_b32 s15, s4
    v_mov_b32 v32, s15
    v_mov_b32 v33, s15
    v_mov_b32 v34, s15
    v_mov_b32 v35, s15
    s_lshl_b32 s15, s11, 2
    s_add_u32 s15, s15, s12
    s_lshl_b32 s15, s15, 10
    s_add_u32 s15, s15, 6815744
    v_lshlrev_b32 v26, 4, v1
    buffer_store_dwordx4 v[32:35], v26, s[48:51], s15 offen
L_nopw:
    v_mul_u32_u24 v26, 5120, v3
    v_lshrrev_b32 v27, 3, v2
    v_mul_u32_u24 v27, 2560, v27
    v_and_b32 v28, 7, v2
    v_lshlrev_b32 v28, 4, v28
    v_add3_u32 v26, v26, v27, v28
    s_lshl_b32 s15, s13, 2
    s_add_u32 s15, s15, 6291456
    s_and_b32 s9, s10, 3
    s_mul_i32 s9, s9, 40960
    s_add_u32 s15, s15, s9
    s_add_u32 s9, s15, 20480
    v_lshlrev_b32 v30, 4, v0
    s_lshl_b32 s8, s3, 9
    s_add_u32 s8, s8, 24576
    v_lshlrev_b32 v27, 4, v2
    v_add_u32 v27, s8, v27
    v_lshrrev_b32 v31, 3, v2
    v_lshlrev_b32 v31, 7, v31
    v_lshl_add_u32 v31, v3, 4, v31
    v_add_u32 v31, s8, v31
    s_waitcnt vmcnt(1)
    s_mov_b32 s5, 0
    s_branch L_H1_l
L_H1:
    s_sleep 1
L_H1_l:
    buffer_load_dwordx4 v[32:35], v26, s[48:51], s15 offen sc1
    buffer_load_dwordx4 v[36:39], v26, s[48:51], s9 offen sc1
    s_waitcnt vmcnt(0)
L_H1_c:
    v_max3_u32 v28, v33, v35, v37
    v_max_u32 v28, v28, v39
    v_min3_u32 v29, v33, v35, v37
    v_min_u32 v29, v29, v39
    s_add_u32 s5, s5, 1
    s_cmp_gt_u32 s5, 200000
    s_cbranch_scc1 L_H1_x
    v_xor_b32 v28, s4, v28
    v_xor_b32 v29, s4, v29
    v_or_b32 v28, v28, v29
    v_cmp_ne_u32 vcc, 0, v28
    s_mov_b64 exec, vcc
    s_cbranch_execnz L_H1
L_H1_x:
    s_mov_b64 exec, -1
    s_mov_b32 s8, 0x3f80
    s_mov_b32 s9, 0x3f800000
    v_lshlrev_b32 v40, 16, v32
    v_and_b32 v41, 0xffff0000, v32
    v_lshlrev_b32 v42, 16, v34
    v_and_b32 v43, 0xffff0000, v34
    v_dot2c_f32_bf16 v40, s8, v36
    v_dot2c_f32_bf16 v41, s9, v36
    v_dot2c_f32_bf16 v42, s8, v38
    v_dot2c_f32_bf16 v43, s9, v38
    s_nop 1
    v_mov_b32 v44, v40
    v_mov_b32 v45, v41
    v_mov_b32 v46, v42
    v_mov_b32 v47, v43
    s_nop 0
    v_permlane16_swap_b32 v40, v44
    v_permlane16_swap_b32 v41, v45
    v_permlane16_swap_b32 v42, v46
    v_permlane16_swap_b32 v43, v47
    s_nop 0
    v_add_f32 v40, v40, v44
    v_add_f32 v41, v41, v45
    v_add_f32 v42, v42, v46
    v_add_f32 v43, v43, v47
    v_mov_b32 v44, v40
    v_mov_b32 v45, v41
    v_mov_b32 v46, v42
    v_mov_b32 v47, v43
    s_nop 0
    v_permlane32_swap_b32 v40, v44
    v_permlane32_swap_b32 v41, v45
    v_permlane32_swap_b32 v42, v46
    v_permlane32_swap_b32 v43, v47
    s_nop 0
    v_add_f32 v40, v40, v44
    v_add_f32 v41, v41, v45
    v_add_f32 v42, v42, v46
    v_add_f32 v43, v43, v47
    v_cvt_pk_bf16_f32 v40, v40, v40
    v_cvt_pk_bf16_f32 v41, v41, v41
    v_cvt_pk_bf16_f32 v42, v42, v42
    v_cvt_pk_bf16_f32 v43, v43, v43
    ds_write_b128 v27, v[40:43]
    s_waitcnt lgkmcnt(0)
    ds_read_b128 v[40:43], v31
    ds_read_b128 v[44:47], v31 offset:64
    s_waitcnt lgkmcnt(0)
    v_and_b32 v8, v40, v4
    v_and_b32 v9, v40, v5
    v_and_b32 v10, v40, v6
    v_and_b32 v11, v40, v7
    v_and_b32 v12, v41, v4
    v_and_b32 v13, v41, v5
    v_and_b32 v14, v41, v6
    v_and_b32 v15, v41, v7
    v_mfma_f32_16x16x32_bf16 v[32:35], v[8:11], v[64:67], 0
    v_and_b32 v8, v42, v4
    v_and_b32 v9, v42, v5
    v_and_b32 v10, v42, v6
    v_and_b32 v11, v42, v7
    v_mfma_f32_16x16x32_bf16 v[32:35], v[12:15], v[68:71], v[32:35]
    v_and_b32 v12, v43, v4
    v_and_b32 v13, v43, v5
    v_and_b32 v14, v43, v6
    v_and_b32 v15, v43, v7
    v_mfma_f32_16x16x32_bf16 v[32:35], v[8:11], v[72:75], v[32:35]
    v_and_b32 v8, v44, v4
    v_and_b32 v9, v44, v5
    v_and_b32 v10, v44, v6
    v_and_b32 v11, v44, v7
    v_mfma_f32_16x16x32_bf16 v[32:35], v[12:15], v[76:79], v[32:35]
    v_and_b32 v12, v45, v4
    v_and_b32 v13, v45, v5
    v_and_b32 v14, v45, v6
    v_and_b32 v15, v45, v7
    v_mfma_f32_16x16x32_bf16 v[32:35], v[8:11], v[80:83], v[32:35]
    v_and_b32 v8, v46, v4
    v_and_b32 v9, v46, v5
    v_and_b32 v10, v46, v6
    v_and_b32 v11, v46, v7
    v_mfma_f32_16x16x32_bf16 v[32:35], v[12:15], v[84:87], v[32:35]
    v_and_b32 v12, v47, v4
    v_and_b32 v13, v47, v5
    v_and_b32 v14, v47, v6
    v_and_b32 v15, v47, v7
    v_mfma_f32_16x16x32_bf16 v[32:35], v[8:11], v[88:91], v[32:35]
    s_nop 1
    v_mfma_f32_16x16x32_bf16 v[32:35], v[12:15], v[92:95], v[32:35]
    s_nop 7
    ds_write_b128 v30, v[32:35] offset:8192
    s_waitcnt lgkmcnt(0)
    s_barrier
    s_cmp_lg_u32 s3, 0
    s_cbranch_scc1 L_F_s3
    v_lshlrev_b32 v27, 4, v1
    s_lshl_b32 s15, s11, 2
    s_add_u32 s15, s15, s12
    s_lshl_b32 s15, s15, 10
    s_add_u32 s15, s15, 65536
    v_mov_b32 v37, s4
    v_mov_b32 v39, s4
    ds_read_b128 v[64:67], v30 offset:8192
    ds_read_b128 v[68:71], v30 offset:9216
    ds_read_b128 v[72:75], v30 offset:10240
    ds_read_b128 v[76:79], v30 offset:11264
    ds_read_b128 v[80:83], v30 offset:12288
    s_waitcnt lgkmcnt(3)
    v_pk_add_f32 v[64:65], v[64:65], v[68:69]
    v_pk_add_f32 v[66:67], v[66:67], v[70:71]
    s_waitcnt lgkmcnt(2)
    v_pk_add_f32 v[64:65], v[64:65], v[72:73]
    v_pk_add_f32 v[66:67], v[66:67], v[74:75]
    s_waitcnt lgkmcnt(1)
    v_pk_add_f32 v[64:65], v[64:65], v[76:77]
    v_pk_add_f32 v[66:67], v[66:67], v[78:79]
    s_waitcnt lgkmcnt(0)
    v_pk_add_f32 v[32:33], v[64:65], v[80:81]
    v_pk_add_f32 v[34:35], v[66:67], v[82:83]
    v_cvt_pk_bf16_f32 v36, v32, v33
    v_cvt_pk_bf16_f32 v38, v34, v35
    s_add_u32 s13, s15, 6750208
    buffer_store_dwordx4 v[36:39], v27, s[48:51], s13 offen
    buffer_store_dwordx4 v[36:39], v27, s[48:51], s15 offen sc1
L_F_s3:
    s_xor_b32 s11, s11, 2
    s_barrier
    s_cmp_lt_u32 s3, 4
    s_cbranch_scc1 L_S3_h2
    v_lshrrev_b32 v24, 2, v2
    v_lshlrev_b32 v24, 3, v24
    v_and_b32 v25, 3, v2
    v_add_u32 v24, v24, v25
    v_and_b32 v25, 15, v24
    v_xor_b32 v25, v25, v3
    v_lshlrev_b32 v25, 4, v25
    v_lshl_add_u32 v25, v24, 8, v25
    s_sub_u32 s8, s3, 4
    s_lshl_b32 s8, s8, 13
    s_add_u32 s8, s8, 32768
    v_add_u32 v25, s8, v25
    s_waitcnt vmcnt(0)
    v_xor_b32 v26, 0, v25
    ds_read_b128 v[64:67], v26 offset:0
    v_xor_b32 v26, 64, v25
    ds_read_b128 v[68:71], v26 offset:0
    v_xor_b32 v26, 128, v25
    ds_read_b128 v[72:75], v26 offset:0
    v_xor_b32 v26, 192, v25
    ds_read_b128 v[76:79], v26 offset:0
    v_xor_b32 v26, 64, v25
    ds_read_b128 v[80:83], v26 offset:1024
    v_xor_b32 v26, 0, v25
    ds_read_b128 v[84:87], v26 offset:1024
    v_xor_b32 v26, 192, v25
    ds_read_b128 v[88:91], v26 offset:1024
    v_xor_b32 v26, 128, v25
    ds_read_b128 v[92:95], v26 offset:1024
    v_and_b32 v26, 1, v2
    v_mul_u32_u24 v27, 320, v26
    v_lshl_add_u32 v27, v3, 4, v27
    v_lshlrev_b32 v28, 15, v26
    v_lshl_add_u32 v28, v3, 4, v28
    s_lshl_b32 s14, s11, 10
    s_lshl_b32 s15, s12, 8
    s_add_u32 s14, s14, s15
    s_sub_u32 s15, s3, 4
    s_lshl_b32 s15, s15, 6
    s_add_u32 s14, s14, s15
    s_add_u32 s14, s14, 196608
    s_mov_b32 s15, 0x3e0293ee
    s_mov_b32 s8, 0x00030003
    s_mov_b32 s9, 0x00030003
    s_waitcnt lgkmcnt(0)
    s_barrier
    ds_read_b128 v[40:43], v27 offset:0
    ds_read_b128 v[44:47], v27 offset:64
    ds_read_b128 v[48:51], v27 offset:128
    ds_read_b128 v[52:55], v27 offset:192
    s_waitcnt lgkmcnt(3)
    v_mfma_f32_16x16x32_bf16 v[32:35], v[64:67], v[40:43], 0
    v_mfma_f32_16x16x32_bf16 v[36:39], v[80:83], v[40:43], 0
    s_waitcnt lgkmcnt(2)
    v_mfma_f32_16x16x32_bf16 v[32:35], v[68:71], v[44:47], v[32:35]
    v_mfma_f32_16x16x32_bf16 v[36:39], v[84:87], v[44:47], v[36:39]
    s_waitcnt lgkmcnt(1)
    v_mfma_f32_16x16x32_bf16 v[32:35], v[72:75], v[48:51], v[32:35]
    v_mfma_f32_16x16x32_bf16 v[36:39], v[88:91], v[48:51], v[36:39]
    s_waitcnt lgkmcnt(0)
    v_mfma_f32_16x16x32_bf16 v[32:35], v[76:79], v[52:55], v[32:35]
    v_mfma_f32_16x16x32_bf16 v[36:39], v[92:95], v[52:55], v[36:39]
    s_nop 6
    v_mul_f32 v32, s15, v32
    v_mul_f32 v33, s15, v33
    v_mul_f32 v34, s15, v34
    v_mul_f32 v35, s15, v35
    v_mul_f32 v36, s15, v36
    v_mul_f32 v37, s15, v37
    v_mul_f32 v38, s15, v38
    v_mul_f32 v39, s15, v39
    v_cvt_pk_bf16_f32 v32, v32, v33
    v_cvt_pk_bf16_f32 v33, v34, v35
    v_cvt_pk_bf16_f32 v34, v36, v37
    v_cvt_pk_bf16_f32 v35, v38, v39
    s_mov_b64 exec, s[8:9]
    buffer_store_dwordx4 v[32:35], v28, s[48:51], s14 offen sc1
    s_mov_b64 exec, -1
    s_branch L_F_late
L_S3_h2:
    s_cmp_lg_u32 s3, 1
    s_cbranch_scc1 L_S3_bar
    v_lshlrev_b32 v26, 4, v1
    s_lshl_b32 s14, s11, 12
    s_add_u32 s14, s14, 65536
    s_mov_b32 s8, 0x3f80
    s_mov_b32 s9, 0x3f800000
    v_lshrrev_b32 v27, 1, v3
    v_mul_u32_u24 v27, 320, v27
    v_lshl_add_u32 v27, v2, 4, v27
    v_and_b32 v28, 1, v3
    v_lshl_add_u32 v27, v28, 3, v27
    s_add_u32 s13, s14, 6750208
    s_mov_b32 s5, 0
L_H2:
    s_add_u32 s5, s5, 1
    s_and_b32 s6, s5, 7
    s_cmp_eq_u32 s6, 0
    s_cbranch_scc1 L_H2_g
    buffer_load_dwordx4 v[32:35], v26, s[48:51], s13 offen offset:0 sc1
    buffer_load_dwordx4 v[36:39], v26, s[48:51], s13 offen offset:1024 sc1
    buffer_load_dwordx4 v[40:43], v26, s[48:51], s13 offen offset:2048 sc1
    buffer_load_dwordx4 v[44:47], v26, s[48:51], s13 offen offset:3072 sc1
    s_branch L_H2_c
L_H2_g:
    buffer_load_dwordx4 v[32:35], v26, s[48:51], s14 offen offset:0 sc1
    buffer_load_dwordx4 v[36:39], v26, s[48:51], s14 offen offset:1024 sc1
    buffer_load_dwordx4 v[40:43], v26, s[48:51], s14 offen offset:2048 sc1
    buffer_load_dwordx4 v[44:47], v26, s[48:51], s14 offen offset:3072 sc1
L_H2_c:
    s_waitcnt vmcnt(0)
    v_max3_u32 v28, v33, v35, v37
    v_max3_u32 v28, v28, v39, v41
    v_max3_u32 v28, v28, v43, v45
    v_max_u32 v28, v28, v47
    v_min3_u32 v29, v33, v35, v37
    v_min3_u32 v29, v29, v39, v41
    v_min3_u32 v29, v29, v43, v45
    v_min_u32 v29, v29, v47
    s_cmp_gt_u32 s5, 200000
    s_cbranch_scc1 L_H2_x
    v_xor_b32 v28, s4, v28
    v_xor_b32 v29, s4, v29
    v_or_b32 v28, v28, v29
    v_cmp_ne_u32 vcc, 0, v28
    s_cbranch_vccnz L_H2
L_H2_x:
    v_lshlrev_b32 v48, 16, v32
    v_and_b32 v49, 0xffff0000, v32
    v_lshlrev_b32 v50, 16, v34
    v_and_b32 v51, 0xffff0000, v34
    v_dot2c_f32_bf16 v48, s8, v36
    v_dot2c_f32_bf16 v49, s9, v36
    v_dot2c_f32_bf16 v50, s8, v38
    v_dot2c_f32_bf16 v51, s9, v38
    v_dot2c_f32_bf16 v48, s8, v40
    v_dot2c_f32_bf16 v49, s9, v40
    v_dot2c_f32_bf16 v50, s8, v42
    v_dot2c_f32_bf16 v51, s9, v42
    v_dot2c_f32_bf16 v48, s8, v44
    v_dot2c_f32_bf16 v49, s9, v44
    v_dot2c_f32_bf16 v50, s8, v46
    v_dot2c_f32_bf16 v51, s9, v46
    s_nop 2
    v_cvt_pk_bf16_f32 v48, v48, v49
    v_cvt_pk_bf16_f32 v49, v50, v51
    ds_write_b64 v27, v[48:49] offset:0
    s_waitcnt lgkmcnt(0)
L_S3_bar:
    s_barrier
L_F_late:
    s_sub_u32 s15, s10, 60
    s_cmp_lt_u32 s15, 4
    s_cbranch_scc1 L_fin
    s_barrier
    s_cmp_ge_u32 s10, 64
    s_cbranch_scc1 L_late2
    s_cmp_lg_u32 s3, 0
    s_cbranch_scc1 L_trig_x
    s_lshl_b32 s15, s10, 6
    s_add_u32 s15, s15, 1015808
    v_mov_b32 v26, s15
    s_mov_b64 exec, 1
    s_mov_b32 s5, 0
    s_branch L_trig_l
L_trig:
    s_sleep 4
L_trig_l:
    buffer_load_dword v27, v26, s[48:51], 0 offen sc1
    s_waitcnt vmcnt(0)
L_trig_c:
    s_add_u32 s5, s5, 1
    s_cmp_gt_u32 s5, 200000
    s_cbranch_scc1 L_trig_x
    v_cmp_ne_u32 vcc, s4, v27
    s_mov_b64 exec, vcc
    s_cbranch_execnz L_trig
L_trig_x:
    s_mov_b64 exec, -1
    s_barrier
L_late2:
    s_cmp_ge_u32 s10, 118
    s_cbranch_scc1 L_S1bf
    s_cmp_ge_u32 s10, 64
    s_cbranch_scc1 L_FFN
    s_cmp_ge_u32 s10, 40
    s_cbranch_scc1 L_S1bh
    s_mov_b32 s52, s26
    s_mov_b32 s53, s27
    s_mov_b32 s54, 5242880
    s_mov_b32 s55, 0x00020000
    s_and_b32 s11, s10, 7
    s_lshr_b32 s12, s10, 3
    s_lshl_b32 s13, s11, 9
    s_lshl_b32 s14, s3, 6
    s_add_u32 s13, s13, s14
    v_lshl_add_u32 v24, v3, 2, s13
    v_mul_u32_u24 v24, 1280, v24
    v_lshl_add_u32 v24, v2, 4, v24
    s_lshl_b32 s14, s12, 8
    buffer_load_dwordx4 v[128:131], v24, s[52:55], s14 offen offset:0 nt
    buffer_load_dwordx4 v[132:135], v24, s[52:55], s14 offen offset:1280 nt
    buffer_load_dwordx4 v[136:139], v24, s[52:55], s14 offen offset:2560 nt
    buffer_load_dwordx4 v[140:143], v24, s[52:55], s14 offen offset:3840 nt
    s_add_u32 s14, s14, 20480
    buffer_load_dwordx4 v[144:147], v24, s[52:55], s14 offen offset:0 nt
    buffer_load_dwordx4 v[148:151], v24, s[52:55], s14 offen offset:1280 nt
    buffer_load_dwordx4 v[152:155], v24, s[52:55], s14 offen offset:2560 nt
    buffer_load_dwordx4 v[156:159], v24, s[52:55], s14 offen offset:3840 nt
    s_add_u32 s14, s14, 20480
    buffer_load_dwordx4 v[160:163], v24, s[52:55], s14 offen offset:0 nt
    buffer_load_dwordx4 v[164:167], v24, s[52:55], s14 offen offset:1280 nt
    buffer_load_dwordx4 v[168:171], v24, s[52:55], s14 offen offset:2560 nt
    buffer_load_dwordx4 v[172:175], v24, s[52:55], s14 offen offset:3840 nt
    s_add_u32 s14, s14, 20480
    buffer_load_dwordx4 v[176:179], v24, s[52:55], s14 offen offset:0 nt
    buffer_load_dwordx4 v[180:183], v24, s[52:55], s14 offen offset:1280 nt
    buffer_load_dwordx4 v[184:187], v24, s[52:55], s14 offen offset:2560 nt
    buffer_load_dwordx4 v[188:191], v24, s[52:55], s14 offen offset:3840 nt
    v_lshrrev_b32 v26, 7, v0
    v_lshlrev_b32 v27, 11, v26
    v_and_b32 v28, 127, v0
    v_lshl_add_u32 v27, v28, 2, v27
    s_lshl_b32 s14, s11, 13
    s_add_u32 s14, s14, 294912
    v_bfe_u32 v28, v0, 6, 1
    v_mul_u32_u24 v28, 2112, v28
    v_lshl_add_u32 v28, v26, 9, v28
    v_lshl_add_u32 v28, v1, 3, v28
    v_lshrrev_b32 v26, 3, v2
    v_mul_u32_u24 v26, 2112, v26
    s_lshl_b32 s15, s3, 8
    v_add_u32 v26, s15, v26
    v_lshl_add_u32 v26, v3, 4, v26
    v_lshlrev_b32 v30, 4, v0
    s_mov_b32 s8, 0x3f80
    s_mov_b32 s9, 0x3f800000
    s_waitcnt vmcnt(0)
    s_lshl_b32 s15, s10, 6
    s_add_u32 s15, s15, 1015840
    v_mov_b32 v31, s15
    s_mov_b64 exec, 1
    s_mov_b32 s5, 0
    s_branch L_w3a_l
L_w3a:
    s_sleep 4
L_w3a_l:
    buffer_load_dword v32, v31, s[48:51], 0 offen sc1
    s_waitcnt vmcnt(0)
L_w3a_c:
    s_add_u32 s5, s5, 1
    s_cmp_gt_u32 s5, 200000
    s_cbranch_scc1 L_w3a_x
    v_cmp_ne_u32 vcc, s4, v32
    s_mov_b64 exec, vcc
    s_cbranch_execnz L_w3a
L_w3a_x:
    s_mov_b64 exec, -1
    s_mov_b64 exec, 1
    s_mov_b32 s5, 0
    s_branch L_H5gate_l
L_H5gate:
    s_sleep 2
L_H5gate_l:
    buffer_load_dword v32, v27, s[48:51], s14 offen sc1
    s_waitcnt vmcnt(0)
L_H5gate_c:
    s_add_u32 s5, s5, 1
    s_cmp_gt_u32 s5, 200000
    s_cbranch_scc1 L_H5gate_x
    v_cmp_eq_u32 vcc, -1, v32
    s_mov_b64 exec, vcc
    s_cbranch_execnz L_H5gate
L_H5gate_x:
    s_mov_b64 exec, -1
    s_mov_b32 s5, 0
    s_branch L_H5_l
L_H5:
L_H5_l:
    buffer_load_dword v32, v27, s[48:51], s14 offen offset:0 sc1
    buffer_load_dword v33, v27, s[48:51], s14 offen offset:512 sc1
    buffer_load_dword v34, v27, s[48:51], s14 offen offset:1024 sc1
    buffer_load_dword v35, v27, s[48:51], s14 offen offset:1536 sc1
    s_waitcnt vmcnt(0)
L_H5_c:
    v_max3_u32 v29, v32, v33, v34
    v_max_u32 v29, v29, v35
    s_add_u32 s5, s5, 1
    s_cmp_gt_u32 s5, 200000
    s_cbranch_scc1 L_H5_x
    v_cmp_eq_u32 vcc, -1, v29
    s_mov_b64 exec, vcc
    s_cbranch_execnz L_H5
L_H5_x:
    s_mov_b64 exec, -1
    v_lshlrev_b32 v36, 16, v32
    v_and_b32 v37, 0xffff0000, v32
    v_dot2c_f32_bf16 v36, s8, v33
    v_dot2c_f32_bf16 v37, s9, v33
    v_dot2c_f32_bf16 v36, s8, v34
    v_dot2c_f32_bf16 v37, s9, v34
    v_dot2c_f32_bf16 v36, s8, v35
    v_dot2c_f32_bf16 v37, s9, v35
    s_nop 2
    v_cvt_pk_bf16_f32 v36, v36, v36
    v_cvt_pk_bf16_f32 v37, v37, v37
    ds_write_b64 v28, v[36:37] offset:0
    s_waitcnt lgkmcnt(0)
    s_barrier
    ds_read_b128 v[40:43], v26 offset:0
    ds_read_b128 v[44:47], v26 offset:64
    ds_read_b128 v[48:51], v26 offset:128
    ds_read_b128 v[52:55], v26 offset:192
    s_waitcnt lgkmcnt(3)
    v_and_b32 v8, v40, v4
    v_and_b32 v9, v40, v5
    v_and_b32 v10, v40, v6
    v_and_b32 v11, v40, v7
    v_and_b32 v12, v41, v4
    v_and_b32 v13, v41, v5
    v_and_b32 v14, v41, v6
    v_and_b32 v15, v41, v7
    v_mfma_f32_16x16x32_bf16 v[32:35], v[8:11], v[128:131], 0
    v_and_b32 v8, v42, v4
    v_and_b32 v9, v42, v5
    v_and_b32 v10, v42, v6
    v_and_b32 v11, v42, v7
    v_mfma_f32_16x16x32_bf16 v[32:35], v[12:15], v[132:135], v[32:35]
    v_and_b32 v12, v43, v4
    v_and_b32 v13, v43, v5
    v_and_b32 v14, v43, v6
    v_and_b32 v15, v43, v7
    s_waitcnt lgkmcnt(2)
    v_mfma_f32_16x16x32_bf16 v[32:35], v[8:11], v[136:139], v[32:35]
    v_and_b32 v8, v44, v4
    v_and_b32 v9, v44, v5
    v_and_b32 v10, v44, v6
    v_and_b32 v11, v44, v7
    v_mfma_f32_16x16x32_bf16 v[32:35], v[12:15], v[140:143], v[32:35]
    v_and_b32 v12, v45, v4
    v_and_b32 v13, v45, v5
    v_and_b32 v14, v45, v6
    v_and_b32 v15, v45, v7
    v_mfma_f32_16x16x32_bf16 v[32:35], v[8:11], v[144:147], v[32:35]
    v_and_b32 v8, v46, v4
    v_and_b32 v9, v46, v5
    v_and_b32 v10, v46, v6
    v_and_b32 v11, v46, v7
    v_mfma_f32_16x16x32_bf16 v[32:35], v[12:15], v[148:151], v[32:35]
    v_and_b32 v12, v47, v4
    v_and_b32 v13, v47, v5
    v_and_b32 v14, v47, v6
    v_and_b32 v15, v47, v7
    s_waitcnt lgkmcnt(1)
    v_mfma_f32_16x16x32_bf16 v[32:35], v[8:11], v[152:155], v[32:35]
    v_and_b32 v8, v48, v4
    v_and_b32 v9, v48, v5
    v_and_b32 v10, v48, v6
    v_and_b32 v11, v48, v7
    v_mfma_f32_16x16x32_bf16 v[32:35], v[12:15], v[156:159], v[32:35]
    v_and_b32 v12, v49, v4
    v_and_b32 v13, v49, v5
    v_and_b32 v14, v49, v6
    v_and_b32 v15, v49, v7
    v_mfma_f32_16x16x32_bf16 v[32:35], v[8:11], v[160:163], v[32:35]
    v_and_b32 v8, v50, v4
    v_and_b32 v9, v50, v5
    v_and_b32 v10, v50, v6
    v_and_b32 v11, v50, v7
    v_mfma_f32_16x16x32_bf16 v[32:35], v[12:15], v[164:167], v[32:35]
    v_and_b32 v12, v51, v4
    v_and_b32 v13, v51, v5
    v_and_b32 v14, v51, v6
    v_and_b32 v15, v51, v7
    s_waitcnt lgkmcnt(0)
    v_mfma_f32_16x16x32_bf16 v[32:35], v[8:11], v[168:171], v[32:35]
    v_and_b32 v8, v52, v4
    v_and_b32 v9, v52, v5
    v_and_b32 v10, v52, v6
    v_and_b32 v11, v52, v7
    v_mfma_f32_16x16x32_bf16 v[32:35], v[12:15], v[172:175], v[32:35]
    v_and_b32 v12, v53, v4
    v_and_b32 v13, v53, v5
    v_and_b32 v14, v53, v6
    v_and_b32 v15, v53, v7
    v_mfma_f32_16x16x32_bf16 v[32:35], v[8:11], v[176:179], v[32:35]
    v_and_b32 v8, v54, v4
    v_and_b32 v9, v54, v5
    v_and_b32 v10, v54, v6
    v_and_b32 v11, v54, v7
    v_mfma_f32_16x16x32_bf16 v[32:35], v[12:15], v[180:183], v[32:35]
    v_and_b32 v12, v55, v4
    v_and_b32 v13, v55, v5
    v_and_b32 v14, v55, v6
    v_and_b32 v15, v55, v7
    v_mfma_f32_16x16x32_bf16 v[32:35], v[8:11], v[184:187], v[32:35]
    s_nop 1
    v_mfma_f32_16x16x32_bf16 v[32:35], v[12:15], v[188:191], v[32:35]
    s_nop 7
    ds_write_b128 v30, v[32:35] offset:8192
    s_waitcnt lgkmcnt(0)
    s_barrier
    s_cmp_lg_u32 s3, 0
    s_cbranch_scc1 L_fin
    v_lshlrev_b32 v27, 3, v1
    s_mul_i32 s14, s11, 2560
    s_lshl_b32 s15, s12, 9
    s_add_u32 s14, s14, s15
    s_add_u32 s14, s14, 835584
    ds_read_b128 v[64:67], v30 offset:8192
    ds_read_b128 v[68:71], v30 offset:9216
    ds_read_b128 v[72:75], v30 offset:10240
    ds_read_b128 v[76:79], v30 offset:11264
    ds_read_b128 v[80:83], v30 offset:12288
    ds_read_b128 v[84:87], v30 offset:13312
    ds_read_b128 v[88:91], v30 offset:14336
    ds_read_b128 v[92:95], v30 offset:15360
    s_waitcnt lgkmcnt(6)
    v_pk_add_f32 v[64:65], v[64:65], v[68:69]
    v_pk_add_f32 v[66:67], v[66:67], v[70:71]
    s_waitcnt lgkmcnt(5)
    v_pk_add_f32 v[64:65], v[64:65], v[72:73]
    v_pk_add_f32 v[66:67], v[66:67], v[74:75]
    s_waitcnt lgkmcnt(4)
    v_pk_add_f32 v[64:65], v[64:65], v[76:77]
    v_pk_add_f32 v[66:67], v[66:67], v[78:79]
    s_waitcnt lgkmcnt(3)
    v_pk_add_f32 v[64:65], v[64:65], v[80:81]
    v_pk_add_f32 v[66:67], v[66:67], v[82:83]
    s_waitcnt lgkmcnt(2)
    v_pk_add_f32 v[64:65], v[64:65], v[84:85]
    v_pk_add_f32 v[66:67], v[66:67], v[86:87]
    s_waitcnt lgkmcnt(1)
    v_pk_add_f32 v[64:65], v[64:65], v[88:89]
    v_pk_add_f32 v[66:67], v[66:67], v[90:91]
    s_waitcnt lgkmcnt(0)
    v_pk_add_f32 v[32:33], v[64:65], v[92:93]
    v_pk_add_f32 v[34:35], v[66:67], v[94:95]
    v_cvt_pk_bf16_f32 v32, v32, v33
    v_cvt_pk_bf16_f32 v33, v34, v35
    buffer_store_dwordx2 v[32:33], v27, s[48:51], s14 offen sc1
    s_add_u32 s14, s14, 20480
    buffer_store_dwordx2 v[32:33], v27, s[48:51], s14 offen sc1
    s_add_u32 s14, s14, 20480
    buffer_store_dwordx2 v[32:33], v27, s[48:51], s14 offen sc1
    s_add_u32 s14, s14, 20480
    buffer_store_dwordx2 v[32:33], v27, s[48:51], s14 offen sc1
    s_add_u32 s14, s14, 20480
    buffer_store_dwordx2 v[32:33], v27, s[48:51], s14 offen sc1
    s_add_u32 s14, s14, 20480
    buffer_store_dwordx2 v[32:33], v27, s[48:51], s14 offen sc1
    s_add_u32 s14, s14, 20480
    buffer_store_dwordx2 v[32:33], v27, s[48:51], s14 offen sc1
    s_add_u32 s14, s14, 20480
    buffer_store_dwordx2 v[32:33], v27, s[48:51], s14 offen sc1
    s_branch L_fin
L_S1bh:
    s_sub_u32 s11, s10, 40
    s_and_b32 s12, s11, 1
    s_lshr_b32 s11, s11, 1
    s_lshl_b32 s87, s11, 10
    s_add_u32 s88, s87, 413696
    s_add_u32 s87, s87, 398336
    s_cmp_eq_u32 s12, 1
    s_cselect_b32 s87, s88, s87
    s_add_u32 s11, s11, 5
    s_mul_i32 s13, s12, 320
    s_lshl_b32 s15, s3, 6
    s_add_u32 s13, s13, s15
    v_lshlrev_b32 v30, 4, v0
    s_cmp_ge_u32 s3, 5
    s_cbranch_scc1 L_S1b_z
    s_mov_b32 s52, s38
    s_mov_b32 s53, s39
    s_mov_b32 s54, 4915200
    s_mov_b32 s55, 0x00020000
    s_mov_b32 s56, s36
    s_mov_b32 s57, s37
    s_mov_b32 s58, 2560
    s_mov_b32 s59, 0x00020000
    v_lshl_add_u32 v24, v3, 2, s13
    v_lshrrev_b32 v25, 3, v2
    v_mul_u32_u24 v26, 1280, v25
    v_lshl_add_u32 v26, v24, 1, v26
    v_mul_u32_u24 v27, 7680, v24
    v_lshl_add_u32 v27, v2, 4, v27
    s_lshl_b32 s14, s11, 8
    s_add_u32 s14, s14, 2560

    buffer_load_dwordx2 v[40:41], v26, s[56:59], 0 offen offset:0
    buffer_load_dwordx2 v[42:43], v26, s[56:59], 0 offen offset:32
    buffer_load_dwordx2 v[44:45], v26, s[56:59], 0 offen offset:64
    buffer_load_dwordx2 v[46:47], v26, s[56:59], 0 offen offset:96
    s_add_u32 s15, s14, 0
    buffer_load_dwordx4 v[128:131], v27, s[52:55], s15 offen nt
    s_add_u32 s15, s14, 7680
    buffer_load_dwordx4 v[132:135], v27, s[52:55], s15 offen nt
    s_add_u32 s15, s14, 15360
    buffer_load_dwordx4 v[136:139], v27, s[52:55], s15 offen nt
    s_add_u32 s15, s14, 23040
    buffer_load_dwordx4 v[140:143], v27, s[52:55], s15 offen nt
    s_add_u32 s15, s14, 122880
    buffer_load_dwordx4 v[144:147], v27, s[52:55], s15 offen nt
    s_add_u32 s15, s14, 130560
    buffer_load_dwordx4 v[148:151], v27, s[52:55], s15 offen nt
    s_add_u32 s15, s14, 138240
    buffer_load_dwordx4 v[152:155], v27, s[52:55], s15 offen nt
    s_add_u32 s15, s14, 145920
    buffer_load_dwordx4 v[156:159], v27, s[52:55], s15 offen nt
    s_add_u32 s15, s14, 245760
    buffer_load_dwordx4 v[160:163], v27, s[52:55], s15 offen nt
    s_add_u32 s15, s14, 253440
    buffer_load_dwordx4 v[164:167], v27, s[52:55], s15 offen nt
    s_add_u32 s15, s14, 261120
    buffer_load_dwordx4 v[168:171], v27, s[52:55], s15 offen nt
    s_add_u32 s15, s14, 268800
    buffer_load_dwordx4 v[172:175], v27, s[52:55], s15 offen nt
    s_add_u32 s15, s14, 368640
    buffer_load_dwordx4 v[176:179], v27, s[52:55], s15 offen nt
    s_add_u32 s15, s14, 376320
    buffer_load_dwordx4 v[180:183], v27, s[52:55], s15 offen nt
    s_add_u32 s15, s14, 384000
    buffer_load_dwordx4 v[184:187], v27, s[52:55], s15 offen nt
    s_add_u32 s15, s14, 391680
    buffer_load_dwordx4 v[188:191], v27, s[52:55], s15 offen nt
    s_waitcnt vmcnt(16)
    v_lshlrev_b32 v64, 16, v40
    v_and_b32 v65, 0xffff0000, v40
    v_lshlrev_b32 v66, 16, v41
    v_and_b32 v67, 0xffff0000, v41
    v_mul_f32 v24, 0xbfb8aa3b, v64
    v_exp_f32 v24, v24
    s_nop 0
    v_add_f32 v24, 1.0, v24
    v_rcp_f32 v24, v24
    s_nop 0
    v_mul_f32 v64, v64, v24
    v_mul_f32 v24, 0xbfb8aa3b, v65
    v_exp_f32 v24, v24
    s_nop 0
    v_add_f32 v24, 1.0, v24
    v_rcp_f32 v24, v24
    s_nop 0
    v_mul_f32 v65, v65, v24
    v_mul_f32 v24, 0xbfb8aa3b, v66
    v_exp_f32 v24, v24
    s_nop 0
    v_add_f32 v24, 1.0, v24
    v_rcp_f32 v24, v24
    s_nop 0
    v_mul_f32 v66, v66, v24
    v_mul_f32 v24, 0xbfb8aa3b, v67
    v_exp_f32 v24, v24
    s_nop 0
    v_add_f32 v24, 1.0, v24
    v_rcp_f32 v24, v24
    s_nop 0
    v_mul_f32 v67, v67, v24
    v_cvt_pk_bf16_f32 v64, v64, v64
    v_cvt_pk_bf16_f32 v65, v65, v65
    v_cvt_pk_bf16_f32 v66, v66, v66
    v_cvt_pk_bf16_f32 v67, v67, v67
    v_lshlrev_b32 v68, 16, v42
    v_and_b32 v69, 0xffff0000, v42
    v_lshlrev_b32 v70, 16, v43
    v_and_b32 v71, 0xffff0000, v43
    v_mul_f32 v24, 0xbfb8aa3b, v68
    v_exp_f32 v24, v24
    s_nop 0
    v_add_f32 v24, 1.0, v24
    v_rcp_f32 v24, v24
    s_nop 0
    v_mul_f32 v68, v68, v24
    v_mul_f32 v24, 0xbfb8aa3b, v69
    v_exp_f32 v24, v24
    s_nop 0
    v_add_f32 v24, 1.0, v24
    v_rcp_f32 v24, v24
    s_nop 0
    v_mul_f32 v69, v69, v24
    v_mul_f32 v24, 0xbfb8aa3b, v70
    v_exp_f32 v24, v24
    s_nop 0
    v_add_f32 v24, 1.0, v24
    v_rcp_f32 v24, v24
    s_nop 0
    v_mul_f32 v70, v70, v24
    v_mul_f32 v24, 0xbfb8aa3b, v71
    v_exp_f32 v24, v24
    s_nop 0
    v_add_f32 v24, 1.0, v24
    v_rcp_f32 v24, v24
    s_nop 0
    v_mul_f32 v71, v71, v24
    v_cvt_pk_bf16_f32 v68, v68, v68
    v_cvt_pk_bf16_f32 v69, v69, v69
    v_cvt_pk_bf16_f32 v70, v70, v70
    v_cvt_pk_bf16_f32 v71, v71, v71
    v_lshlrev_b32 v72, 16, v44
    v_and_b32 v73, 0xffff0000, v44
    v_lshlrev_b32 v74, 16, v45
    v_and_b32 v75, 0xffff0000, v45
    v_mul_f32 v24, 0xbfb8aa3b, v72
    v_exp_f32 v24, v24
    s_nop 0
    v_add_f32 v24, 1.0, v24
    v_rcp_f32 v24, v24
    s_nop 0
    v_mul_f32 v72, v72, v24
    v_mul_f32 v24, 0xbfb8aa3b, v73
    v_exp_f32 v24, v24
    s_nop 0
    v_add_f32 v24, 1.0, v24
    v_rcp_f32 v24, v24
    s_nop 0
    v_mul_f32 v73, v73, v24
    v_mul_f32 v24, 0xbfb8aa3b, v74
    v_exp_f32 v24, v24
    s_nop 0
    v_add_f32 v24, 1.0, v24
    v_rcp_f32 v24, v24
    s_nop 0
    v_mul_f32 v74, v74, v24
    v_mul_f32 v24, 0xbfb8aa3b, v75
    v_exp_f32 v24, v24
    s_nop 0
    v_add_f32 v24, 1.0, v24
    v_rcp_f32 v24, v24
    s_nop 0
    v_mul_f32 v75, v75, v24
    v_cvt_pk_bf16_f32 v72, v72, v72
    v_cvt_pk_bf16_f32 v73, v73, v73
    v_cvt_pk_bf16_f32 v74, v74, v74
    v_cvt_pk_bf16_f32 v75, v75, v75
    v_lshlrev_b32 v76, 16, v46
    v_and_b32 v77, 0xffff0000, v46
    v_lshlrev_b32 v78, 16, v47
    v_and_b32 v79, 0xffff0000, v47
    v_mul_f32 v24, 0xbfb8aa3b, v76
    v_exp_f32 v24, v24
    s_nop 0
    v_add_f32 v24, 1.0, v24
    v_rcp_f32 v24, v24
    s_nop 0
    v_mul_f32 v76, v76, v24
    v_mul_f32 v24, 0xbfb8aa3b, v77
    v_exp_f32 v24, v24
    s_nop 0
    v_add_f32 v24, 1.0, v24
    v_rcp_f32 v24, v24
    s_nop 0
    v_mul_f32 v77, v77, v24
    v_mul_f32 v24, 0xbfb8aa3b, v78
    v_exp_f32 v24, v24
    s_nop 0
    v_add_f32 v24, 1.0, v24
    v_rcp_f32 v24, v24
    s_nop 0
    v_mul_f32 v78, v78, v24
    v_mul_f32 v24, 0xbfb8aa3b, v79
    v_exp_f32 v24, v24
    s_nop 0
    v_add_f32 v24, 1.0, v24
    v_rcp_f32 v24, v24
    s_nop 0
    v_mul_f32 v79, v79, v24
    v_cvt_pk_bf16_f32 v76, v76, v76
    v_cvt_pk_bf16_f32 v77, v77, v77
    v_cvt_pk_bf16_f32 v78, v78, v78
    v_cvt_pk_bf16_f32 v79, v79, v79
    v_lshlrev_b32 v30, 4, v0
    v_and_b32 v8, v64, v4
    v_and_b32 v9, v64, v5
    v_and_b32 v10, v64, v6
    v_and_b32 v11, v64, v7
    v_and_b32 v12, v65, v4
    v_and_b32 v13, v65, v5
    v_and_b32 v14, v65, v6
    v_and_b32 v15, v65, v7
    s_waitcnt vmcnt(15)
    v_mfma_f32_16x16x32_bf16 v[32:35], v[8:11], v[128:131], 0
    v_and_b32 v8, v66, v4
    v_and_b32 v9, v66, v5
    v_and_b32 v10, v66, v6
    v_and_b32 v11, v66, v7
    s_waitcnt vmcnt(14)
    v_mfma_f32_16x16x32_bf16 v[32:35], v[12:15], v[132:135], v[32:35]
    v_and_b32 v12, v67, v4
    v_and_b32 v13, v67, v5
    v_and_b32 v14, v67, v6
    v_and_b32 v15, v67, v7
    s_waitcnt vmcnt(13)
    v_mfma_f32_16x16x32_bf16 v[32:35], v[8:11], v[136:139], v[32:35]
    v_and_b32 v8, v68, v4
    v_and_b32 v9, v68, v5
    v_and_b32 v10, v68, v6
    v_and_b32 v11, v68, v7
    s_waitcnt vmcnt(12)
    v_mfma_f32_16x16x32_bf16 v[32:35], v[12:15], v[140:143], v[32:35]
    v_and_b32 v12, v69, v4
    v_and_b32 v13, v69, v5
    v_and_b32 v14, v69, v6
    v_and_b32 v15, v69, v7
    s_waitcnt vmcnt(11)
    v_mfma_f32_16x16x32_bf16 v[32:35], v[8:11], v[144:147], v[32:35]
    v_and_b32 v8, v70, v4
    v_and_b32 v9, v70, v5
    v_and_b32 v10, v70, v6
    v_and_b32 v11, v70, v7
    s_waitcnt vmcnt(10)
    v_mfma_f32_16x16x32_bf16 v[32:35], v[12:15], v[148:151], v[32:35]
    v_and_b32 v12, v71, v4
    v_and_b32 v13, v71, v5
    v_and_b32 v14, v71, v6
    v_and_b32 v15, v71, v7
    s_waitcnt vmcnt(9)
    v_mfma_f32_16x16x32_bf16 v[32:35], v[8:11], v[152:155], v[32:35]
    v_and_b32 v8, v72, v4
    v_and_b32 v9, v72, v5
    v_and_b32 v10, v72, v6
    v_and_b32 v11, v72, v7
    s_waitcnt vmcnt(8)
    v_mfma_f32_16x16x32_bf16 v[32:35], v[12:15], v[156:159], v[32:35]
    v_and_b32 v12, v73, v4
    v_and_b32 v13, v73, v5
    v_and_b32 v14, v73, v6
    v_and_b32 v15, v73, v7
    s_waitcnt vmcnt(7)
    v_mfma_f32_16x16x32_bf16 v[32:35], v[8:11], v[160:163], v[32:35]
    v_and_b32 v8, v74, v4
    v_and_b32 v9, v74, v5
    v_and_b32 v10, v74, v6
    v_and_b32 v11, v74, v7
    s_waitcnt vmcnt(6)
    v_mfma_f32_16x16x32_bf16 v[32:35], v[12:15], v[164:167], v[32:35]
    v_and_b32 v12, v75, v4
    v_and_b32 v13, v75, v5
    v_and_b32 v14, v75, v6
    v_and_b32 v15, v75, v7
    s_waitcnt vmcnt(5)
    v_mfma_f32_16x16x32_bf16 v[32:35], v[8:11], v[168:171], v[32:35]
    v_and_b32 v8, v76, v4
    v_and_b32 v9, v76, v5
    v_and_b32 v10, v76, v6
    v_and_b32 v11, v76, v7
    s_waitcnt vmcnt(4)
    v_mfma_f32_16x16x32_bf16 v[32:35], v[12:15], v[172:175], v[32:35]
    v_and_b32 v12, v77, v4
    v_and_b32 v13, v77, v5
    v_and_b32 v14, v77, v6
    v_and_b32 v15, v77, v7
    s_waitcnt vmcnt(3)
    v_mfma_f32_16x16x32_bf16 v[32:35], v[8:11], v[176:179], v[32:35]
    v_and_b32 v8, v78, v4
    v_and_b32 v9, v78, v5
    v_and_b32 v10, v78, v6
    v_and_b32 v11, v78, v7
    s_waitcnt vmcnt(2)
    v_mfma_f32_16x16x32_bf16 v[32:35], v[12:15], v[180:183], v[32:35]
    v_and_b32 v12, v79, v4
    v_and_b32 v13, v79, v5
    v_and_b32 v14, v79, v6
    v_and_b32 v15, v79, v7
    s_waitcnt vmcnt(1)
    v_mfma_f32_16x16x32_bf16 v[32:35], v[8:11], v[184:187], v[32:35]
    s_nop 1
    s_waitcnt vmcnt(0)
    v_mfma_f32_16x16x32_bf16 v[32:35], v[12:15], v[188:191], v[32:35]
    s_nop 7
    ds_write_b128 v30, v[32:35] offset:8192
    s_waitcnt lgkmcnt(0)
    s_branch L_S1b_fin
L_S1b_z:
    v_mov_b32 v32, 0
    v_mov_b32 v33, 0
    v_mov_b32 v34, 0
    v_mov_b32 v35, 0
    ds_write_b128 v30, v[32:35] offset:8192
    s_waitcnt lgkmcnt(0)
    s_branch L_S1b_fin
L_S1bf:
    s_sub_u32 s11, s10, 118
    s_add_u32 s12, s11, 10
    s_cmp_lt_u32 s11, 5
    s_cselect_b32 s11, s11, s12
    s_lshl_b32 s87, s11, 10
    s_add_u32 s87, s87, 393216
    s_mul_i32 s13, s3, 80
    s_mov_b32 s52, s38
    s_mov_b32 s53, s39
    s_mov_b32 s54, 4915200
    s_mov_b32 s55, 0x00020000
    s_mov_b32 s56, s36
    s_mov_b32 s57, s37
    s_mov_b32 s58, 2560
    s_mov_b32 s59, 0x00020000
    v_lshl_add_u32 v24, v3, 2, s13
    v_lshrrev_b32 v25, 3, v2
    v_mul_u32_u24 v26, 1280, v25
    v_lshl_add_u32 v26, v24, 1, v26
    v_mul_u32_u24 v27, 7680, v24
    v_lshl_add_u32 v27, v2, 4, v27
    s_lshl_b32 s14, s11, 8
    s_add_u32 s14, s14, 2560

    buffer_load_dwordx2 v[40:41], v26, s[56:59], 0 offen offset:0
    buffer_load_dwordx2 v[42:43], v26, s[56:59], 0 offen offset:32
    buffer_load_dwordx2 v[44:45], v26, s[56:59], 0 offen offset:64
    buffer_load_dwordx2 v[46:47], v26, s[56:59], 0 offen offset:96
    buffer_load_dwordx2 v[48:49], v26, s[56:59], 0 offen offset:128
    s_add_u32 s15, s14, 0
    buffer_load_dwordx4 v[128:131], v27, s[52:55], s15 offen nt
    s_add_u32 s15, s14, 7680
    buffer_load_dwordx4 v[132:135], v27, s[52:55], s15 offen nt
    s_add_u32 s15, s14, 15360
    buffer_load_dwordx4 v[136:139], v27, s[52:55], s15 offen nt
    s_add_u32 s15, s14, 23040
    buffer_load_dwordx4 v[140:143], v27, s[52:55], s15 offen nt
    s_add_u32 s15, s14, 122880
    buffer_load_dwordx4 v[144:147], v27, s[52:55], s15 offen nt
    s_add_u32 s15, s14, 130560
    buffer_load_dwordx4 v[148:151], v27, s[52:55], s15 offen nt
    s_add_u32 s15, s14, 138240
    buffer_load_dwordx4 v[152:155], v27, s[52:55], s15 offen nt
    s_add_u32 s15, s14, 145920
    buffer_load_dwordx4 v[156:159], v27, s[52:55], s15 offen nt
    s_add_u32 s15, s14, 245760
    buffer_load_dwordx4 v[160:163], v27, s[52:55], s15 offen nt
    s_add_u32 s15, s14, 253440
    buffer_load_dwordx4 v[164:167], v27, s[52:55], s15 offen nt
    s_add_u32 s15, s14, 261120
    buffer_load_dwordx4 v[168:171], v27, s[52:55], s15 offen nt
    s_add_u32 s15, s14, 268800
    buffer_load_dwordx4 v[172:175], v27, s[52:55], s15 offen nt
    s_add_u32 s15, s14, 368640
    buffer_load_dwordx4 v[176:179], v27, s[52:55], s15 offen nt
    s_add_u32 s15, s14, 376320
    buffer_load_dwordx4 v[180:183], v27, s[52:55], s15 offen nt
    s_add_u32 s15, s14, 384000
    buffer_load_dwordx4 v[184:187], v27, s[52:55], s15 offen nt
    s_add_u32 s15, s14, 391680
    buffer_load_dwordx4 v[188:191], v27, s[52:55], s15 offen nt
    s_add_u32 s15, s14, 491520
    buffer_load_dwordx4 v[192:195], v27, s[52:55], s15 offen nt
    s_add_u32 s15, s14, 499200
    buffer_load_dwordx4 v[196:199], v27, s[52:55], s15 offen nt
    s_add_u32 s15, s14, 506880
    buffer_load_dwordx4 v[200:203], v27, s[52:55], s15 offen nt
    s_add_u32 s15, s14, 514560
    buffer_load_dwordx4 v[204:207], v27, s[52:55], s15 offen nt
    s_waitcnt vmcnt(20)
    v_lshlrev_b32 v64, 16, v40
    v_and_b32 v65, 0xffff0000, v40
    v_lshlrev_b32 v66, 16, v41
    v_and_b32 v67, 0xffff0000, v41
    v_mul_f32 v24, 0xbfb8aa3b, v64
    v_exp_f32 v24, v24
    s_nop 0
    v_add_f32 v24, 1.0, v24
    v_rcp_f32 v24, v24
    s_nop 0
    v_mul_f32 v64, v64, v24
    v_mul_f32 v24, 0xbfb8aa3b, v65
    v_exp_f32 v24, v24
    s_nop 0
    v_add_f32 v24, 1.0, v24
    v_rcp_f32 v24, v24
    s_nop 0
    v_mul_f32 v65, v65, v24
    v_mul_f32 v24, 0xbfb8aa3b, v66
    v_exp_f32 v24, v24
    s_nop 0
    v_add_f32 v24, 1.0, v24
    v_rcp_f32 v24, v24
    s_nop 0
    v_mul_f32 v66, v66, v24
    v_mul_f32 v24, 0xbfb8aa3b, v67
    v_exp_f32 v24, v24
    s_nop 0
    v_add_f32 v24, 1.0, v24
    v_rcp_f32 v24, v24
    s_nop 0
    v_mul_f32 v67, v67, v24
    v_cvt_pk_bf16_f32 v64, v64, v64
    v_cvt_pk_bf16_f32 v65, v65, v65
    v_cvt_pk_bf16_f32 v66, v66, v66
    v_cvt_pk_bf16_f32 v67, v67, v67
    v_lshlrev_b32 v68, 16, v42
    v_and_b32 v69, 0xffff0000, v42
    v_lshlrev_b32 v70, 16, v43
    v_and_b32 v71, 0xffff0000, v43
    v_mul_f32 v24, 0xbfb8aa3b, v68
    v_exp_f32 v24, v24
    s_nop 0
    v_add_f32 v24, 1.0, v24
    v_rcp_f32 v24, v24
    s_nop 0
    v_mul_f32 v68, v68, v24
    v_mul_f32 v24, 0xbfb8aa3b, v69
    v_exp_f32 v24, v24
    s_nop 0
    v_add_f32 v24, 1.0, v24
    v_rcp_f32 v24, v24
    s_nop 0
    v_mul_f32 v69, v69, v24
    v_mul_f32 v24, 0xbfb8aa3b, v70
    v_exp_f32 v24, v24
    s_nop 0
    v_add_f32 v24, 1.0, v24
    v_rcp_f32 v24, v24
    s_nop 0
    v_mul_f32 v70, v70, v24
    v_mul_f32 v24, 0xbfb8aa3b, v71
    v_exp_f32 v24, v24
    s_nop 0
    v_add_f32 v24, 1.0, v24
    v_rcp_f32 v24, v24
    s_nop 0
    v_mul_f32 v71, v71, v24
    v_cvt_pk_bf16_f32 v68, v68, v68
    v_cvt_pk_bf16_f32 v69, v69, v69
    v_cvt_pk_bf16_f32 v70, v70, v70
    v_cvt_pk_bf16_f32 v71, v71, v71
    v_lshlrev_b32 v72, 16, v44
    v_and_b32 v73, 0xffff0000, v44
    v_lshlrev_b32 v74, 16, v45
    v_and_b32 v75, 0xffff0000, v45
    v_mul_f32 v24, 0xbfb8aa3b, v72
    v_exp_f32 v24, v24
    s_nop 0
    v_add_f32 v24, 1.0, v24
    v_rcp_f32 v24, v24
    s_nop 0
    v_mul_f32 v72, v72, v24
    v_mul_f32 v24, 0xbfb8aa3b, v73
    v_exp_f32 v24, v24
    s_nop 0
    v_add_f32 v24, 1.0, v24
    v_rcp_f32 v24, v24
    s_nop 0
    v_mul_f32 v73, v73, v24
    v_mul_f32 v24, 0xbfb8aa3b, v74
    v_exp_f32 v24, v24
    s_nop 0
    v_add_f32 v24, 1.0, v24
    v_rcp_f32 v24, v24
    s_nop 0
    v_mul_f32 v74, v74, v24
    v_mul_f32 v24, 0xbfb8aa3b, v75
    v_exp_f32 v24, v24
    s_nop 0
    v_add_f32 v24, 1.0, v24
    v_rcp_f32 v24, v24
    s_nop 0
    v_mul_f32 v75, v75, v24
    v_cvt_pk_bf16_f32 v72, v72, v72
    v_cvt_pk_bf16_f32 v73, v73, v73
    v_cvt_pk_bf16_f32 v74, v74, v74
    v_cvt_pk_bf16_f32 v75, v75, v75
    v_lshlrev_b32 v76, 16, v46
    v_and_b32 v77, 0xffff0000, v46
    v_lshlrev_b32 v78, 16, v47
    v_and_b32 v79, 0xffff0000, v47
    v_mul_f32 v24, 0xbfb8aa3b, v76
    v_exp_f32 v24, v24
    s_nop 0
    v_add_f32 v24, 1.0, v24
    v_rcp_f32 v24, v24
    s_nop 0
    v_mul_f32 v76, v76, v24
    v_mul_f32 v24, 0xbfb8aa3b, v77
    v_exp_f32 v24, v24
    s_nop 0
    v_add_f32 v24, 1.0, v24
    v_rcp_f32 v24, v24
    s_nop 0
    v_mul_f32 v77, v77, v24
    v_mul_f32 v24, 0xbfb8aa3b, v78
    v_exp_f32 v24, v24
    s_nop 0
    v_add_f32 v24, 1.0, v24
    v_rcp_f32 v24, v24
    s_nop 0
    v_mul_f32 v78, v78, v24
    v_mul_f32 v24, 0xbfb8aa3b, v79
    v_exp_f32 v24, v24
    s_nop 0
    v_add_f32 v24, 1.0, v24
    v_rcp_f32 v24, v24
    s_nop 0
    v_mul_f32 v79, v79, v24
    v_cvt_pk_bf16_f32 v76, v76, v76
    v_cvt_pk_bf16_f32 v77, v77, v77
    v_cvt_pk_bf16_f32 v78, v78, v78
    v_cvt_pk_bf16_f32 v79, v79, v79
    v_lshlrev_b32 v80, 16, v48
    v_and_b32 v81, 0xffff0000, v48
    v_lshlrev_b32 v82, 16, v49
    v_and_b32 v83, 0xffff0000, v49
    v_mul_f32 v24, 0xbfb8aa3b, v80
    v_exp_f32 v24, v24
    s_nop 0
    v_add_f32 v24, 1.0, v24
    v_rcp_f32 v24, v24
    s_nop 0
    v_mul_f32 v80, v80, v24
    v_mul_f32 v24, 0xbfb8aa3b, v81
    v_exp_f32 v24, v24
    s_nop 0
    v_add_f32 v24, 1.0, v24
    v_rcp_f32 v24, v24
    s_nop 0
    v_mul_f32 v81, v81, v24
    v_mul_f32 v24, 0xbfb8aa3b, v82
    v_exp_f32 v24, v24
    s_nop 0
    v_add_f32 v24, 1.0, v24
    v_rcp_f32 v24, v24
    s_nop 0
    v_mul_f32 v82, v82, v24
    v_mul_f32 v24, 0xbfb8aa3b, v83
    v_exp_f32 v24, v24
    s_nop 0
    v_add_f32 v24, 1.0, v24
    v_rcp_f32 v24, v24
    s_nop 0
    v_mul_f32 v83, v83, v24
    v_cvt_pk_bf16_f32 v80, v80, v80
    v_cvt_pk_bf16_f32 v81, v81, v81
    v_cvt_pk_bf16_f32 v82, v82, v82
    v_cvt_pk_bf16_f32 v83, v83, v83
    v_lshlrev_b32 v30, 4, v0
    v_and_b32 v8, v64, v4
    v_and_b32 v9, v64, v5
    v_and_b32 v10, v64, v6
    v_and_b32 v11, v64, v7
    v_and_b32 v12, v65, v4
    v_and_b32 v13, v65, v5
    v_and_b32 v14, v65, v6
    v_and_b32 v15, v65, v7
    s_waitcnt vmcnt(19)
    v_mfma_f32_16x16x32_bf16 v[32:35], v[8:11], v[128:131], 0
    v_and_b32 v8, v66, v4
    v_and_b32 v9, v66, v5
    v_and_b32 v10, v66, v6
    v_and_b32 v11, v66, v7
    s_waitcnt vmcnt(18)
    v_mfma_f32_16x16x32_bf16 v[32:35], v[12:15], v[132:135], v[32:35]
    v_and_b32 v12, v67, v4
    v_and_b32 v13, v67, v5
    v_and_b32 v14, v67, v6
    v_and_b32 v15, v67, v7
    s_waitcnt vmcnt(17)
    v_mfma_f32_16x16x32_bf16 v[32:35], v[8:11], v[136:139], v[32:35]
    v_and_b32 v8, v68, v4
    v_and_b32 v9, v68, v5
    v_and_b32 v10, v68, v6
    v_and_b32 v11, v68, v7
    s_waitcnt vmcnt(16)
    v_mfma_f32_16x16x32_bf16 v[32:35], v[12:15], v[140:143], v[32:35]
    v_and_b32 v12, v69, v4
    v_and_b32 v13, v69, v5
    v_and_b32 v14, v69, v6
    v_and_b32 v15, v69, v7
    s_waitcnt vmcnt(15)
    v_mfma_f32_16x16x32_bf16 v[32:35], v[8:11], v[144:147], v[32:35]
    v_and_b32 v8, v70, v4
    v_and_b32 v9, v70, v5
    v_and_b32 v10, v70, v6
    v_and_b32 v11, v70, v7
    s_waitcnt vmcnt(14)
    v_mfma_f32_16x16x32_bf16 v[32:35], v[12:15], v[148:151], v[32:35]
    v_and_b32 v12, v71, v4
    v_and_b32 v13, v71, v5
    v_and_b32 v14, v71, v6
    v_and_b32 v15, v71, v7
    s_waitcnt vmcnt(13)
    v_mfma_f32_16x16x32_bf16 v[32:35], v[8:11], v[152:155], v[32:35]
    v_and_b32 v8, v72, v4
    v_and_b32 v9, v72, v5
    v_and_b32 v10, v72, v6
    v_and_b32 v11, v72, v7
    s_waitcnt vmcnt(12)
    v_mfma_f32_16x16x32_bf16 v[32:35], v[12:15], v[156:159], v[32:35]
    v_and_b32 v12, v73, v4
    v_and_b32 v13, v73, v5
    v_and_b32 v14, v73, v6
    v_and_b32 v15, v73, v7
    s_waitcnt vmcnt(11)
    v_mfma_f32_16x16x32_bf16 v[32:35], v[8:11], v[160:163], v[32:35]
    v_and_b32 v8, v74, v4
    v_and_b32 v9, v74, v5
    v_and_b32 v10, v74, v6
    v_and_b32 v11, v74, v7
    s_waitcnt vmcnt(10)
    v_mfma_f32_16x16x32_bf16 v[32:35], v[12:15], v[164:167], v[32:35]
    v_and_b32 v12, v75, v4
    v_and_b32 v13, v75, v5
    v_and_b32 v14, v75, v6
    v_and_b32 v15, v75, v7
    s_waitcnt vmcnt(9)
    v_mfma_f32_16x16x32_bf16 v[32:35], v[8:11], v[168:171], v[32:35]
    v_and_b32 v8, v76, v4
    v_and_b32 v9, v76, v5
    v_and_b32 v10, v76, v6
    v_and_b32 v11, v76, v7
    s_waitcnt vmcnt(8)
    v_mfma_f32_16x16x32_bf16 v[32:35], v[12:15], v[172:175], v[32:35]
    v_and_b32 v12, v77, v4
    v_and_b32 v13, v77, v5
    v_and_b32 v14, v77, v6
    v_and_b32 v15, v77, v7
    s_waitcnt vmcnt(7)
    v_mfma_f32_16x16x32_bf16 v[32:35], v[8:11], v[176:179], v[32:35]
    v_and_b32 v8, v78, v4
    v_and_b32 v9, v78, v5
    v_and_b32 v10, v78, v6
    v_and_b32 v11, v78, v7
    s_waitcnt vmcnt(6)
    v_mfma_f32_16x16x32_bf16 v[32:35], v[12:15], v[180:183], v[32:35]
    v_and_b32 v12, v79, v4
    v_and_b32 v13, v79, v5
    v_and_b32 v14, v79, v6
    v_and_b32 v15, v79, v7
    s_waitcnt vmcnt(5)
    v_mfma_f32_16x16x32_bf16 v[32:35], v[8:11], v[184:187], v[32:35]
    v_and_b32 v8, v80, v4
    v_and_b32 v9, v80, v5
    v_and_b32 v10, v80, v6
    v_and_b32 v11, v80, v7
    s_waitcnt vmcnt(4)
    v_mfma_f32_16x16x32_bf16 v[32:35], v[12:15], v[188:191], v[32:35]
    v_and_b32 v12, v81, v4
    v_and_b32 v13, v81, v5
    v_and_b32 v14, v81, v6
    v_and_b32 v15, v81, v7
    s_waitcnt vmcnt(3)
    v_mfma_f32_16x16x32_bf16 v[32:35], v[8:11], v[192:195], v[32:35]
    v_and_b32 v8, v82, v4
    v_and_b32 v9, v82, v5
    v_and_b32 v10, v82, v6
    v_and_b32 v11, v82, v7
    s_waitcnt vmcnt(2)
    v_mfma_f32_16x16x32_bf16 v[32:35], v[12:15], v[196:199], v[32:35]
    v_and_b32 v12, v83, v4
    v_and_b32 v13, v83, v5
    v_and_b32 v14, v83, v6
    v_and_b32 v15, v83, v7
    s_waitcnt vmcnt(1)
    v_mfma_f32_16x16x32_bf16 v[32:35], v[8:11], v[200:203], v[32:35]
    s_nop 1
    s_waitcnt vmcnt(0)
    v_mfma_f32_16x16x32_bf16 v[32:35], v[12:15], v[204:207], v[32:35]
    s_nop 7
    ds_write_b128 v30, v[32:35] offset:8192
    s_waitcnt lgkmcnt(0)
L_S1b_fin:
    s_barrier
    s_cmp_lg_u32 s3, 0
    s_cbranch_scc1 L_fin
    s_lshl_b32 s15, s10, 6
    s_add_u32 s15, s15, 1015840
    v_mov_b32 v31, s15
    s_mov_b64 exec, 1
    s_mov_b32 s5, 0
    s_branch L_w3b_l
L_w3b:
    s_sleep 4
L_w3b_l:
    buffer_load_dword v32, v31, s[48:51], 0 offen sc1
    s_waitcnt vmcnt(0)
L_w3b_c:
    s_add_u32 s5, s5, 1
    s_cmp_gt_u32 s5, 200000
    s_cbranch_scc1 L_w3b_x
    v_cmp_ne_u32 vcc, s4, v32
    s_mov_b64 exec, vcc
    s_cbranch_execnz L_w3b
L_w3b_x:
    s_mov_b64 exec, -1
    v_lshlrev_b32 v27, 4, v1
    ds_read_b128 v[64:67], v30 offset:8192
    ds_read_b128 v[68:71], v30 offset:9216
    ds_read_b128 v[72:75], v30 offset:10240
    ds_read_b128 v[76:79], v30 offset:11264
    ds_read_b128 v[80:83], v30 offset:12288
    ds_read_b128 v[84:87], v30 offset:13312
    ds_read_b128 v[88:91], v30 offset:14336
    ds_read_b128 v[92:95], v30 offset:15360
    s_waitcnt lgkmcnt(6)
    v_pk_add_f32 v[64:65], v[64:65], v[68:69]
    v_pk_add_f32 v[66:67], v[66:67], v[70:71]
    s_waitcnt lgkmcnt(5)
    v_pk_add_f32 v[64:65], v[64:65], v[72:73]
    v_pk_add_f32 v[66:67], v[66:67], v[74:75]
    s_waitcnt lgkmcnt(4)
    v_pk_add_f32 v[64:65], v[64:65], v[76:77]
    v_pk_add_f32 v[66:67], v[66:67], v[78:79]
    s_waitcnt lgkmcnt(3)
    v_pk_add_f32 v[64:65], v[64:65], v[80:81]
    v_pk_add_f32 v[66:67], v[66:67], v[82:83]
    s_waitcnt lgkmcnt(2)
    v_pk_add_f32 v[64:65], v[64:65], v[84:85]
    v_pk_add_f32 v[66:67], v[66:67], v[86:87]
    s_waitcnt lgkmcnt(1)
    v_pk_add_f32 v[64:65], v[64:65], v[88:89]
    v_pk_add_f32 v[66:67], v[66:67], v[90:91]
    s_waitcnt lgkmcnt(0)
    v_pk_add_f32 v[32:33], v[64:65], v[92:93]
    v_pk_add_f32 v[34:35], v[66:67], v[94:95]
    buffer_store_dwordx4 v[32:35], v27, s[48:51], s87 offen sc1
    s_branch L_fin
L_FFN:
    s_mov_b32 s52, s30
    s_mov_b32 s53, s31
    s_mov_b32 s54, 2211840
    s_mov_b32 s55, 0x00020000
    s_mov_b32 s56, s32
    s_mov_b32 s57, s33
    s_mov_b32 s58, 2211840
    s_mov_b32 s59, 0x00020000
    s_mov_b32 s60, s34
    s_mov_b32 s61, s35
    s_mov_b32 s62, 2211840
    s_mov_b32 s63, 0x00020000
    s_mov_b32 s64, s16
    s_mov_b32 s65, s17
    s_mov_b32 s66, 2560
    s_mov_b32 s67, 0x00020000
    s_sub_u32 s11, s10, 64
    s_cmp_lg_u32 s3, 4
    s_cbranch_scc1 L_FFN_np
    s_setprio 2
L_FFN_np:
    s_mul_i32 s13, s3, 80
    v_lshl_add_u32 v24, v3, 2, s13
    v_lshrrev_b32 v25, 3, v2
    v_add_u32 v24, v24, v25
    v_mul_u32_u24 v24, 3456, v24
    v_and_b32 v25, 3, v2
    v_lshl_add_u32 v24, v25, 4, v24
    s_lshl_b32 s14, s11, 6
    s_mov_b32 s8, 0x0f0f0f0f
    s_mov_b32 s9, 0x0f0f0f0f
    s_mov_b64 exec, s[8:9]
    s_add_u32 s15, s14, 0
    buffer_load_dwordx4 v[64:67], v24, s[52:55], s15 offen nt
    s_add_u32 s15, s14, 6912
    buffer_load_dwordx4 v[68:71], v24, s[52:55], s15 offen nt
    s_add_u32 s15, s14, 55296
    buffer_load_dwordx4 v[72:75], v24, s[52:55], s15 offen nt
    s_add_u32 s15, s14, 62208
    buffer_load_dwordx4 v[76:79], v24, s[52:55], s15 offen nt
    s_add_u32 s15, s14, 110592
    buffer_load_dwordx4 v[80:83], v24, s[52:55], s15 offen nt
    s_add_u32 s15, s14, 117504
    buffer_load_dwordx4 v[84:87], v24, s[52:55], s15 offen nt
    s_add_u32 s15, s14, 165888
    buffer_load_dwordx4 v[88:91], v24, s[52:55], s15 offen nt
    s_add_u32 s15, s14, 172800
    buffer_load_dwordx4 v[92:95], v24, s[52:55], s15 offen nt
    s_add_u32 s15, s14, 221184
    buffer_load_dwordx4 v[96:99], v24, s[52:55], s15 offen nt
    s_add_u32 s15, s14, 228096
    buffer_load_dwordx4 v[100:103], v24, s[52:55], s15 offen nt
    s_not_b64 exec, exec
    s_add_u32 s15, s14, 0
    buffer_load_dwordx4 v[64:67], v24, s[56:59], s15 offen nt
    s_add_u32 s15, s14, 6912
    buffer_load_dwordx4 v[68:71], v24, s[56:59], s15 offen nt
    s_add_u32 s15, s14, 55296
    buffer_load_dwordx4 v[72:75], v24, s[56:59], s15 offen nt
    s_add_u32 s15, s14, 62208
    buffer_load_dwordx4 v[76:79], v24, s[56:59], s15 offen nt
    s_add_u32 s15, s14, 110592
    buffer_load_dwordx4 v[80:83], v24, s[56:59], s15 offen nt
    s_add_u32 s15, s14, 117504
    buffer_load_dwordx4 v[84:87], v24, s[56:59], s15 offen nt
    s_add_u32 s15, s14, 165888
    buffer_load_dwordx4 v[88:91], v24, s[56:59], s15 offen nt
    s_add_u32 s15, s14, 172800
    buffer_load_dwordx4 v[92:95], v24, s[56:59], s15 offen nt
    s_add_u32 s15, s14, 221184
    buffer_load_dwordx4 v[96:99], v24, s[56:59], s15 offen nt
    s_add_u32 s15, s14, 228096
    buffer_load_dwordx4 v[100:103], v24, s[56:59], s15 offen nt
    s_mov_b64 exec, -1
    v_and_b32 v24, 1, v2
    v_lshlrev_b32 v24, 4, v24
    v_mov_b32 v25, 0xffff
    v_lshlrev_b32 v24, v24, v25
    v_and_b32 v25, 2, v2
    v_cmp_eq_u32 vcc, 0, v25
    s_nop 1
    v_cndmask_b32 v16, 0, v24, vcc
    v_cndmask_b32 v17, v24, 0, vcc
    v_lshlrev_b32 v20, 3, v0
    v_add_u32 v27, 5120, v20
    v_lshlrev_b32 v30, 4, v0
    v_lshrrev_b32 v23, 2, v2
    v_and_b32 v23, 1, v23
    v_mul_u32_u24 v23, 2624, v23
    s_mul_i32 s15, s3, 320
    v_lshl_add_u32 v24, v3, 4, s15
    v_add_u32 v23, v23, v24
    v_lshrrev_b32 v29, 5, v1
    v_lshlrev_b32 v28, 8, v29
    v_bfe_u32 v24, v1, 2, 1
    v_lshl_add_u32 v28, v24, 7, v28
    v_bfe_u32 v24, v1, 3, 2
    v_lshl_add_u32 v28, v24, 4, v28
    v_and_b32 v24, 3, v1
    v_lshl_add_u32 v28, v24, 2, v28
    v_add_u32 v28, 8192, v28
    v_mul_u32_u24 v22, 192, v29
    v_and_b32 v25, 31, v1
    v_lshl_add_u32 v22, v25, 2, v22
    s_cmp_ge_u32 s3, 5
    s_cbranch_scc1 L_FFN_x1
    s_lshl_b32 s13, s11, 5
    v_lshl_add_u32 v24, v3, 2, s13
    v_mul_u32_u24 v24, 1280, v24
    v_lshl_add_u32 v24, v2, 4, v24
    s_lshl_b32 s14, s3, 8
    s_add_u32 s15, s14, 20480
    buffer_load_dwordx4 v[104:107], v24, s[60:63], s14 offen offset:0 nt
    buffer_load_dwordx4 v[108:111], v24, s[60:63], s14 offen offset:1280 nt
    buffer_load_dwordx4 v[112:115], v24, s[60:63], s14 offen offset:2560 nt
    buffer_load_dwordx4 v[116:119], v24, s[60:63], s14 offen offset:3840 nt
    buffer_load_dwordx4 v[120:123], v24, s[60:63], s15 offen offset:0 nt
    buffer_load_dwordx4 v[124:127], v24, s[60:63], s15 offen offset:1280 nt
    buffer_load_dwordx4 v[128:131], v24, s[60:63], s15 offen offset:2560 nt
    buffer_load_dwordx4 v[132:135], v24, s[60:63], s15 offen offset:3840 nt
    v_lshrrev_b32 v18, 1, v3
    v_mul_u32_u24 v18, 1280, v18
    v_lshl_add_u32 v18, v2, 4, v18
    v_and_b32 v19, 1, v3
    v_lshl_add_u32 v18, v19, 3, v18
    v_lshrrev_b32 v21, 1, v3
    v_mul_u32_u24 v21, 2624, v21
    v_lshl_add_u32 v21, v2, 5, v21
    v_and_b32 v19, 1, v3
    v_lshl_add_u32 v21, v19, 4, v21
    buffer_load_dwordx2 v[48:49], v18, s[64:67], s14 offen
    s_lshl_b32 s14, s3, 9
    v_add_u32 v21, s14, v21
    s_setprio 0
L_FFN_x1:
    s_waitcnt vmcnt(0)
    v_mov_b32 v24, v66
    v_mov_b32 v25, v67
    v_mov_b32_dpp v66, v64 row_ror:8 row_mask:0xf bank_mask:0x3
    v_mov_b32_dpp v67, v65 row_ror:8 row_mask:0xf bank_mask:0x3
    v_mov_b32_dpp v64, v24 row_ror:8 row_mask:0xf bank_mask:0xc
    v_mov_b32_dpp v65, v25 row_ror:8 row_mask:0xf bank_mask:0xc
    v_mov_b32 v24, v70
    v_mov_b32 v25, v71
    v_mov_b32_dpp v70, v68 row_ror:8 row_mask:0xf bank_mask:0x3
    v_mov_b32_dpp v71, v69 row_ror:8 row_mask:0xf bank_mask:0x3
    v_mov_b32_dpp v68, v24 row_ror:8 row_mask:0xf bank_mask:0xc
    v_mov_b32_dpp v69, v25 row_ror:8 row_mask:0xf bank_mask:0xc
    v_mov_b32 v24, v74
    v_mov_b32 v25, v75
    v_mov_b32_dpp v74, v72 row_ror:8 row_mask:0xf bank_mask:0x3
    v_mov_b32_dpp v75, v73 row_ror:8 row_mask:0xf bank_mask:0x3
    v_mov_b32_dpp v72, v24 row_ror:8 row_mask:0xf bank_mask:0xc
    v_mov_b32_dpp v73, v25 row_ror:8 row_mask:0xf bank_mask:0xc
    v_mov_b32 v24, v78
    v_mov_b32 v25, v79
    v_mov_b32_dpp v78, v76 row_ror:8 row_mask:0xf bank_mask:0x3
    v_mov_b32_dpp v79, v77 row_ror:8 row_mask:0xf bank_mask:0x3
    v_mov_b32_dpp v76, v24 row_ror:8 row_mask:0xf bank_mask:0xc
    v_mov_b32_dpp v77, v25 row_ror:8 row_mask:0xf bank_mask:0xc
    v_mov_b32 v24, v82
    v_mov_b32 v25, v83
    v_mov_b32_dpp v82, v80 row_ror:8 row_mask:0xf bank_mask:0x3
    v_mov_b32_dpp v83, v81 row_ror:8 row_mask:0xf bank_mask:0x3
    v_mov_b32_dpp v80, v24 row_ror:8 row_mask:0xf bank_mask:0xc
    v_mov_b32_dpp v81, v25 row_ror:8 row_mask:0xf bank_mask:0xc
    v_mov_b32 v24, v86
    v_mov_b32 v25, v87
    v_mov_b32_dpp v86, v84 row_ror:8 row_mask:0xf bank_mask:0x3
    v_mov_b32_dpp v87, v85 row_ror:8 row_mask:0xf bank_mask:0x3
    v_mov_b32_dpp v84, v24 row_ror:8 row_mask:0xf bank_mask:0xc
    v_mov_b32_dpp v85, v25 row_ror:8 row_mask:0xf bank_mask:0xc
    v_mov_b32 v24, v90
    v_mov_b32 v25, v91
    v_mov_b32_dpp v90, v88 row_ror:8 row_mask:0xf bank_mask:0x3
    v_mov_b32_dpp v91, v89 row_ror:8 row_mask:0xf bank_mask:0x3
    v_mov_b32_dpp v88, v24 row_ror:8 row_mask:0xf bank_mask:0xc
    v_mov_b32_dpp v89, v25 row_ror:8 row_mask:0xf bank_mask:0xc
    v_mov_b32 v24, v94
    v_mov_b32 v25, v95
    v_mov_b32_dpp v94, v92 row_ror:8 row_mask:0xf bank_mask:0x3
    v_mov_b32_dpp v95, v93 row_ror:8 row_mask:0xf bank_mask:0x3
    v_mov_b32_dpp v92, v24 row_ror:8 row_mask:0xf bank_mask:0xc
    v_mov_b32_dpp v93, v25 row_ror:8 row_mask:0xf bank_mask:0xc
    v_mov_b32 v24, v98
    v_mov_b32 v25, v99
    v_mov_b32_dpp v98, v96 row_ror:8 row_mask:0xf bank_mask:0x3
    v_mov_b32_dpp v99, v97 row_ror:8 row_mask:0xf bank_mask:0x3
    v_mov_b32_dpp v96, v24 row_ror:8 row_mask:0xf bank_mask:0xc
    v_mov_b32_dpp v97, v25 row_ror:8 row_mask:0xf bank_mask:0xc
    v_mov_b32 v24, v102
    v_mov_b32 v25, v103
    v_mov_b32_dpp v102, v100 row_ror:8 row_mask:0xf bank_mask:0x3
    v_mov_b32_dpp v103, v101 row_ror:8 row_mask:0xf bank_mask:0x3
    v_mov_b32_dpp v100, v24 row_ror:8 row_mask:0xf bank_mask:0xc
    v_mov_b32_dpp v101, v25 row_ror:8 row_mask:0xf bank_mask:0xc
    s_cmp_ge_u32 s3, 5
    s_cbranch_scc1 L_FFN_b1
    s_lshl_b32 s15, s10, 6
    s_add_u32 s15, s15, 1015840
    v_mov_b32 v31, s15
    s_mov_b32 s13, 393216
    s_mov_b32 s12, 398336
    s_mov_b32 s14, 403456
    s_mov_b32 s9, 408576
    s_mov_b32 s8, 413696
    s_mov_b32 s15, 418816
    s_mov_b64 exec, 1
    s_mov_b32 s5, 0
    s_branch L_w3c_l
L_w3c:
    s_sleep 4
L_w3c_l:
    buffer_load_dword v32, v31, s[48:51], 0 offen sc1
    s_waitcnt vmcnt(0)
L_w3c_c:
    s_add_u32 s5, s5, 1
    s_cmp_gt_u32 s5, 200000
    s_cbranch_scc1 L_w3c_x
    v_cmp_ne_u32 vcc, s4, v32
    s_mov_b64 exec, vcc
    s_cbranch_execnz L_w3c
L_w3c_x:
    s_mov_b64 exec, -1
    s_mov_b32 s5, 0
    s_branch L_R8_l
L_R8:
    s_sleep 6
L_R8_l:
    buffer_load_dwordx4 v[208:211], v30, s[48:51], s13 offen sc1
    buffer_load_dwordx4 v[212:215], v30, s[48:51], s12 offen sc1
    buffer_load_dwordx4 v[216:219], v30, s[48:51], s14 offen sc1
    buffer_load_dwordx4 v[220:223], v30, s[48:51], s9 offen sc1
    buffer_load_dwordx4 v[224:227], v30, s[48:51], s8 offen sc1
    buffer_load_dwordx4 v[228:231], v30, s[48:51], s15 offen sc1
    s_waitcnt vmcnt(0)
L_R8_c:
    v_max3_u32 v31, v208, v209, v210
    v_max3_u32 v31, v31, v211, v212
    v_max3_u32 v31, v31, v213, v214
    v_max3_u32 v31, v31, v215, v216
    v_max3_u32 v31, v31, v217, v218
    v_max3_u32 v31, v31, v219, v220
    v_max3_u32 v31, v31, v221, v222
    v_max3_u32 v31, v31, v223, v224
    v_max3_u32 v31, v31, v225, v226
    v_max3_u32 v31, v31, v227, v228
    v_max3_u32 v31, v31, v229, v230
    v_max_u32 v31, v31, v231
    s_add_u32 s5, s5, 1
    s_cmp_gt_u32 s5, 200000
    s_cbranch_scc1 L_R8_x
    v_cmp_eq_u32 vcc, -1, v31
    s_mov_b64 exec, vcc
    s_cbranch_execnz L_R8
L_R8_x:
    s_mov_b64 exec, -1
    v_add_f32 v212, v212, v224
    v_add_f32 v213, v213, v225
    v_add_f32 v214, v214, v226
    v_add_f32 v215, v215, v227
    v_add_f32 v216, v216, v228
    v_add_f32 v217, v217, v229
    v_add_f32 v218, v218, v230
    v_add_f32 v219, v219, v231
    v_lshlrev_b32 v52, 16, v48
    v_and_b32 v53, 0xffff0000, v48
    v_lshlrev_b32 v54, 16, v49
    v_and_b32 v55, 0xffff0000, v49
    v_add_f32 v216, 1.0, v216
    v_add_f32 v217, 1.0, v217
    v_add_f32 v218, 1.0, v218
    v_add_f32 v219, 1.0, v219
    s_mov_b32 s8, 0x3f80
    s_mov_b32 s9, 0x3f800000
    s_and_b32 s13, s11, 7
    s_mul_i32 s13, s13, 20480
    s_add_u32 s13, s13, 835584
    s_add_u32 s12, s13, 10240
    v_lshrrev_b32 v19, 5, v0
    v_lshlrev_b32 v19, 3, v19
    v_lshlrev_b32 v18, 3, v29
    s_mov_b64 exec, 1
    s_mov_b32 s5, 0
    s_branch L_H6gate_l
L_H6gate:
    s_sleep 2
L_H6gate_l:
    buffer_load_dword v32, v20, s[48:51], s13 offen sc1
    s_waitcnt vmcnt(0)
L_H6gate_c:
    s_add_u32 s5, s5, 1
    s_cmp_gt_u32 s5, 200000
    s_cbranch_scc1 L_H6gate_x
    v_cmp_eq_u32 vcc, -1, v32
    s_mov_b64 exec, vcc
    s_cbranch_execnz L_H6gate
L_H6gate_x:
    s_mov_b64 exec, -1
    s_mov_b32 s5, 0
    s_branch L_H6_l
L_H6:
L_H6_l:
    buffer_load_dwordx2 v[32:33], v20, s[48:51], s13 offen offset:0 sc1
    buffer_load_dwordx2 v[34:35], v20, s[48:51], s13 offen offset:2560 sc1
    buffer_load_dwordx2 v[36:37], v27, s[48:51], s13 offen offset:0 sc1
    buffer_load_dwordx2 v[38:39], v27, s[48:51], s13 offen offset:2560 sc1
    buffer_load_dwordx2 v[40:41], v20, s[48:51], s12 offen offset:0 sc1
    buffer_load_dwordx2 v[42:43], v20, s[48:51], s12 offen offset:2560 sc1
    buffer_load_dwordx2 v[44:45], v27, s[48:51], s12 offen offset:0 sc1
    buffer_load_dwordx2 v[46:47], v27, s[48:51], s12 offen offset:2560 sc1
    s_waitcnt vmcnt(0)
L_H6_c:
    v_max3_u32 v31, v32, v33, v34
    v_max3_u32 v31, v31, v35, v36
    v_max3_u32 v31, v31, v37, v38
    v_max3_u32 v31, v31, v39, v40
    v_max3_u32 v31, v31, v41, v42
    v_max3_u32 v31, v31, v43, v44
    v_max3_u32 v31, v31, v45, v46
    v_max_u32 v31, v31, v47
    s_add_u32 s5, s5, 1
    s_cmp_gt_u32 s5, 200000
    s_cbranch_scc1 L_H6_x
    v_cmp_eq_u32 vcc, -1, v31
    s_mov_b64 exec, vcc
    s_cbranch_execnz L_H6
L_H6_x:
    s_mov_b64 exec, -1
    v_lshlrev_b32 v56, 16, v32
    v_and_b32 v57, 0xffff0000, v32
    v_lshlrev_b32 v58, 16, v33
    v_and_b32 v59, 0xffff0000, v33
    v_dot2c_f32_bf16 v56, s8, v34
    v_dot2c_f32_bf16 v57, s9, v34
    v_dot2c_f32_bf16 v58, s8, v35
    v_dot2c_f32_bf16 v59, s9, v35
    v_dot2c_f32_bf16 v56, s8, v36
    v_dot2c_f32_bf16 v57, s9, v36
    v_dot2c_f32_bf16 v58, s8, v37
    v_dot2c_f32_bf16 v59, s9, v37
    v_dot2c_f32_bf16 v56, s8, v38
    v_dot2c_f32_bf16 v57, s9, v38
    v_dot2c_f32_bf16 v58, s8, v39
    v_dot2c_f32_bf16 v59, s9, v39
    v_dot2c_f32_bf16 v56, s8, v40
    v_dot2c_f32_bf16 v57, s9, v40
    v_dot2c_f32_bf16 v58, s8, v41
    v_dot2c_f32_bf16 v59, s9, v41
    v_dot2c_f32_bf16 v56, s8, v42
    v_dot2c_f32_bf16 v57, s9, v42
    v_dot2c_f32_bf16 v58, s8, v43
    v_dot2c_f32_bf16 v59, s9, v43
    v_dot2c_f32_bf16 v56, s8, v44
    v_dot2c_f32_bf16 v57, s9, v44
    v_dot2c_f32_bf16 v58, s8, v45
    v_dot2c_f32_bf16 v59, s9, v45
    v_dot2c_f32_bf16 v56, s8, v46
    v_dot2c_f32_bf16 v57, s9, v46
    v_dot2c_f32_bf16 v58, s8, v47
    v_dot2c_f32_bf16 v59, s9, v47
    s_nop 2
    v_fmac_f32 v52, v208, v56
    v_fmac_f32 v53, v209, v57
    v_fmac_f32 v54, v210, v58
    v_fmac_f32 v55, v211, v59
    v_add_f32 v40, v52, v53
    v_mul_f32 v41, v52, v52
    v_add_f32 v42, v54, v55
    v_fmac_f32 v41, v53, v53
    v_add_f32 v40, v40, v42
    v_fmac_f32 v41, v54, v54
    v_fmac_f32 v41, v55, v55
    s_nop 0
    v_add_f32_dpp v40, v40, v40 row_ror:8 row_mask:0xf bank_mask:0xf
    v_add_f32_dpp v41, v41, v41 row_ror:8 row_mask:0xf bank_mask:0xf
    s_nop 0
    v_add_f32_dpp v40, v40, v40 row_ror:4 row_mask:0xf bank_mask:0xf
    v_add_f32_dpp v41, v41, v41 row_ror:4 row_mask:0xf bank_mask:0xf
    s_nop 0
    v_add_f32_dpp v40, v40, v40 row_ror:2 row_mask:0xf bank_mask:0xf
    v_add_f32_dpp v41, v41, v41 row_ror:2 row_mask:0xf bank_mask:0xf
    s_nop 0
    v_add_f32_dpp v40, v40, v40 row_ror:1 row_mask:0xf bank_mask:0xf
    v_add_f32_dpp v41, v41, v41 row_ror:1 row_mask:0xf bank_mask:0xf
    v_mov_b32 v42, v40
    v_mov_b32 v43, v41
    s_nop 0
    v_permlane16_swap_b32 v40, v42
    v_permlane16_swap_b32 v41, v43
    s_nop 0
    v_add_f32 v40, v40, v42
    v_add_f32 v41, v41, v43
    ds_write_b64 v19, v[40:41] offset:21504
    s_waitcnt lgkmcnt(0)
    s_barrier
    ds_read_b64 v[152:153], v18 offset:21504
    ds_read_b64 v[154:155], v18 offset:21520
    ds_read_b64 v[156:157], v18 offset:21536
    ds_read_b64 v[158:159], v18 offset:21552
    ds_read_b64 v[160:161], v18 offset:21568
    s_waitcnt lgkmcnt(0)
    v_pk_add_f32 v[152:153], v[152:153], v[154:155]
    v_pk_add_f32 v[156:157], v[156:157], v[158:159]
    v_pk_add_f32 v[152:153], v[152:153], v[160:161]
    v_pk_add_f32 v[152:153], v[152:153], v[156:157]
    v_mul_f32 v152, 0x3acccccd, v152
    v_mul_f32 v153, 0x3acccccd, v153
    v_fma_f32 v153, -v152, v152, v153
    v_max_f32 v153, 0, v153
    v_add_f32 v153, 0x3727c5ac, v153
    v_rsq_f32 v153, v153
    v_sub_f32 v56, v52, v152
    v_sub_f32 v57, v53, v152
    v_sub_f32 v58, v54, v152
    v_sub_f32 v59, v55, v152
    v_mul_f32 v56, v56, v153
    v_mul_f32 v57, v57, v153
    v_mul_f32 v58, v58, v153
    v_mul_f32 v59, v59, v153
    v_fma_f32 v56, v56, v216, v212
    v_fma_f32 v57, v57, v217, v213
    v_fma_f32 v58, v58, v218, v214
    v_fma_f32 v59, v59, v219, v215
    v_cvt_pk_bf16_f32 v56, v56, v56
    v_cvt_pk_bf16_f32 v57, v57, v57
    v_cvt_pk_bf16_f32 v58, v58, v58
    v_cvt_pk_bf16_f32 v59, v59, v59
    ds_write_b128 v21, v[56:59] offset:0
    s_waitcnt lgkmcnt(0)
    s_branch L_FFN_main
L_FFN_b1:
    s_barrier
L_FFN_main:
    s_barrier
    ds_read_b128 v[224:227], v23 offset:0
    ds_read_b128 v[228:231], v23 offset:64
    ds_read_b128 v[232:235], v23 offset:128
    ds_read_b128 v[236:239], v23 offset:192
    ds_read_b128 v[240:243], v23 offset:256
    s_waitcnt lgkmcnt(4)
    v_and_b32 v8, v224, v16
    v_and_b32 v9, v224, v17
    v_and_b32 v10, v225, v16
    v_and_b32 v11, v225, v17
    v_and_b32 v12, v226, v16
    v_and_b32 v13, v226, v17
    v_and_b32 v14, v227, v16
    v_and_b32 v15, v227, v17
    s_waitcnt lgkmcnt(3)
    v_mfma_f32_16x16x32_bf16 v[32:35], v[8:11], v[64:67], 0
    v_and_b32 v8, v228, v16
    v_and_b32 v9, v228, v17
    v_and_b32 v10, v229, v16
    v_and_b32 v11, v229, v17
    v_mfma_f32_16x16x32_bf16 v[32:35], v[12:15], v[68:71], v[32:35]
    v_and_b32 v12, v230, v16
    v_and_b32 v13, v230, v17
    v_and_b32 v14, v231, v16
    v_and_b32 v15, v231, v17
    s_waitcnt lgkmcnt(2)
    v_mfma_f32_16x16x32_bf16 v[32:35], v[8:11], v[72:75], v[32:35]
    v_and_b32 v8, v232, v16
    v_and_b32 v9, v232, v17
    v_and_b32 v10, v233, v16
    v_and_b32 v11, v233, v17
    v_mfma_f32_16x16x32_bf16 v[32:35], v[12:15], v[76:79], v[32:35]
    v_and_b32 v12, v234, v16
    v_and_b32 v13, v234, v17
    v_and_b32 v14, v235, v16
    v_and_b32 v15, v235, v17
    s_waitcnt lgkmcnt(1)
    v_mfma_f32_16x16x32_bf16 v[32:35], v[8:11], v[80:83], v[32:35]
    v_and_b32 v8, v236, v16
    v_and_b32 v9, v236, v17
    v_and_b32 v10, v237, v16
    v_and_b32 v11, v237, v17
    v_mfma_f32_16x16x32_bf16 v[32:35], v[12:15], v[84:87], v[32:35]
    v_and_b32 v12, v238, v16
    v_and_b32 v13, v238, v17
    v_and_b32 v14, v239, v16
    v_and_b32 v15, v239, v17
    s_waitcnt lgkmcnt(0)
    v_mfma_f32_16x16x32_bf16 v[32:35], v[8:11], v[88:91], v[32:35]
    v_and_b32 v8, v240, v16
    v_and_b32 v9, v240, v17
    v_and_b32 v10, v241, v16
    v_and_b32 v11, v241, v17
    v_mfma_f32_16x16x32_bf16 v[32:35], v[12:15], v[92:95], v[32:35]
    v_and_b32 v12, v242, v16
    v_and_b32 v13, v242, v17
    v_and_b32 v14, v243, v16
    v_and_b32 v15, v243, v17
    v_mfma_f32_16x16x32_bf16 v[32:35], v[8:11], v[96:99], v[32:35]
    s_nop 1
    v_mfma_f32_16x16x32_bf16 v[32:35], v[12:15], v[100:103], v[32:35]
    v_lshrrev_b32 v24, 3, v2
    v_mul_u32_u24 v24, 192, v24
    v_lshl_add_u32 v24, v3, 4, v24
    s_cmp_eq_u32 s11, 0
    s_cselect_b32 s15, 1.0, 0
    s_mul_i32 s14, s11, 5120
    s_add_u32 s14, s14, 425984
    s_nop 0
    ds_write_b128 v30, v[32:35] offset:8192
    v_mul_f32 v52, s15, v52
    v_mul_f32 v53, s15, v53
    v_mul_f32 v54, s15, v54
    v_mul_f32 v55, s15, v55
    s_waitcnt lgkmcnt(0)
    s_barrier
    s_cmp_lg_u32 s3, 7
    s_cbranch_scc1 L_FFN_b3
    ds_read_b32 v136, v28 offset:0
    ds_read_b32 v137, v28 offset:64
    ds_read_b32 v138, v28 offset:1024
    ds_read_b32 v139, v28 offset:1088
    ds_read_b32 v140, v28 offset:2048
    ds_read_b32 v141, v28 offset:2112
    ds_read_b32 v142, v28 offset:3072
    ds_read_b32 v143, v28 offset:3136
    ds_read_b32 v144, v28 offset:4096
    ds_read_b32 v145, v28 offset:4160
    ds_read_b32 v146, v28 offset:5120
    ds_read_b32 v147, v28 offset:5184
    ds_read_b32 v148, v28 offset:6144
    ds_read_b32 v149, v28 offset:6208
    ds_read_b32 v150, v28 offset:7168
    ds_read_b32 v151, v28 offset:7232
    s_waitcnt lgkmcnt(8)
    v_pk_add_f32 v[136:137], v[136:137], v[138:139]
    v_pk_add_f32 v[140:141], v[140:141], v[142:143]
    v_pk_add_f32 v[136:137], v[136:137], v[140:141]
    s_waitcnt lgkmcnt(0)
    v_pk_add_f32 v[144:145], v[144:145], v[146:147]
    v_pk_add_f32 v[148:149], v[148:149], v[150:151]
    v_pk_add_f32 v[144:145], v[144:145], v[148:149]
    v_pk_add_f32 v[32:33], v[136:137], v[144:145]
    v_mul_f32 v34, 0xbfb8aa3b, v32
    v_exp_f32 v34, v34
    s_nop 0
    v_add_f32 v34, 1.0, v34
    v_rcp_f32 v34, v34
    s_nop 0
    v_mul_f32 v32, v32, v34
    v_mul_f32 v32, v32, v33
    v_cvt_pk_bf16_f32 v32, v32, v32
    ds_write_b32 v22, v32 offset:22528
    s_waitcnt lgkmcnt(0)
L_FFN_b3:
    s_barrier
    s_cmp_ge_u32 s3, 5
    s_cbranch_scc1 L_fin
    ds_read_b128 v[224:227], v24 offset:22528
    ds_read_b128 v[228:231], v24 offset:22592
    s_waitcnt lgkmcnt(1)
    v_and_b32 v8, v224, v4
    v_and_b32 v9, v224, v5
    v_and_b32 v10, v224, v6
    v_and_b32 v11, v224, v7
    v_and_b32 v12, v225, v4
    v_and_b32 v13, v225, v5
    v_and_b32 v14, v225, v6
    v_and_b32 v15, v225, v7
    v_mfma_f32_16x16x32_bf16 v[32:35], v[8:11], v[104:107], 0
    v_and_b32 v8, v226, v4
    v_and_b32 v9, v226, v5
    v_and_b32 v10, v226, v6
    v_and_b32 v11, v226, v7
    v_mfma_f32_16x16x32_bf16 v[32:35], v[12:15], v[108:111], v[32:35]
    v_and_b32 v12, v227, v4
    v_and_b32 v13, v227, v5
    v_and_b32 v14, v227, v6
    v_and_b32 v15, v227, v7
    s_waitcnt lgkmcnt(0)
    v_mfma_f32_16x16x32_bf16 v[32:35], v[8:11], v[112:115], v[32:35]
    v_and_b32 v8, v228, v4
    v_and_b32 v9, v228, v5
    v_and_b32 v10, v228, v6
    v_and_b32 v11, v228, v7
    v_mfma_f32_16x16x32_bf16 v[32:35], v[12:15], v[116:119], v[32:35]
    v_and_b32 v12, v229, v4
    v_and_b32 v13, v229, v5
    v_and_b32 v14, v229, v6
    v_and_b32 v15, v229, v7
    v_mfma_f32_16x16x32_bf16 v[32:35], v[8:11], v[120:123], v[32:35]
    v_and_b32 v8, v230, v4
    v_and_b32 v9, v230, v5
    v_and_b32 v10, v230, v6
    v_and_b32 v11, v230, v7
    v_mfma_f32_16x16x32_bf16 v[32:35], v[12:15], v[124:127], v[32:35]
    v_and_b32 v12, v231, v4
    v_and_b32 v13, v231, v5
    v_and_b32 v14, v231, v6
    v_and_b32 v15, v231, v7
    v_mfma_f32_16x16x32_bf16 v[32:35], v[8:11], v[128:131], v[32:35]
    s_nop 1
    v_mfma_f32_16x16x32_bf16 v[32:35], v[12:15], v[132:135], v[32:35]
    s_nop 7
    v_fmac_f32 v52, v32, v220
    v_fmac_f32 v53, v33, v221
    v_fmac_f32 v54, v34, v222
    v_fmac_f32 v55, v35, v223
    buffer_store_dwordx4 v[52:55], v30, s[48:51], s14 offen sc1
L_fin:
L_end:
    s_endpgm
L_code_end:
    s_endpgm
.section .rodata,"a"
.p2align 6
.amdhsa_kernel adaLN_cond__compressed_kv_cla__swiglu_ffn__decode_kernel
  .amdhsa_next_free_vgpr 256
  .amdhsa_next_free_sgpr 102
  .amdhsa_accum_offset 256
  .amdhsa_group_segment_fixed_size 0
  .amdhsa_kernarg_size 120
  .amdhsa_user_sgpr_count 2
  .amdhsa_user_sgpr_kernarg_segment_ptr 1
  .amdhsa_system_sgpr_workgroup_id_x 1
.end_amdhsa_kernel
```
